```python
import torch

def _softmax(x, axis=-1):
    return torch.softmax(x, dim=axis)
def _gelu(x):
    return torch.nn.functional.gelu(x, approximate="tanh")
def _silu(x):
    return torch.nn.functional.silu(x)
def _sigmoid(x):
    return torch.sigmoid(x)
def _layernorm(x, axis=-1, eps=1e-5):
    m = x.mean(dim=axis, keepdim=True)
    v = x.var(dim=axis, keepdim=True, unbiased=False)
    return (x - m) / torch.sqrt(v + eps)
def _scatter_add(tgt, idx, src, axis=0):
    return tgt.clone().index_add_(axis, idx, src)
def _segment_sum(src, seg, n):
    out = torch.zeros((n,) + src.shape[1:], dtype=src.dtype)
    return out.index_add_(0, seg, src)
def _pad(x, pw):
    flat = tuple(v for pair in reversed(pw) for v in pair)
    return torch.nn.functional.pad(x, flat)

kernel_name = 'parallel_sum__gqa_block_cached__dense_activation_squared_relu__decode'

def setup_inputs():

    _w = (lambda a: (lambda t: t.to(torch.bfloat16) if t.is_floating_point() else t)(torch.as_tensor(a)))
    def _A_setup():
        B, Sq, D = 8, 1, 512
        Hq, Hkv, Sk, Dh = 32, 32, 4096, 128
        assert Hq % Hkv == 0, (Hq, Hkv)
        return {
            "x": _w((lambda *s: torch.randn(*s, dtype=torch.bfloat16) * 0.05)(B, Sq, D)),
            "k_cache": _w((lambda *s: torch.randn(*s, dtype=torch.bfloat16) * 1.6)(B, Hkv, Sk, Dh)),
            "v_cache": _w((lambda *s: torch.randn(*s, dtype=torch.bfloat16) * 3.2)(B, Hkv, Sk, Dh)),
            "wq": _w((lambda *s: torch.randn(*s, dtype=torch.bfloat16) * 1.6)(D, Hq * Dh) * (D ** -0.5)),
            "wo": _w((lambda *s: torch.randn(*s, dtype=torch.bfloat16) * 3.2)(Hq * Dh, D) * ((Hq * Dh) ** -0.5)),
        }
    _A_in = _A_setup()

    def _B_setup():
        B, S, D, F = 8, 1, 512, 1376
        return {
            "x": _w((lambda *s: torch.randn(*s, dtype=torch.bfloat16) * 0.05)(B, S, D)),
            "w1": _w((lambda *s: torch.randn(*s, dtype=torch.bfloat16) * 0.05)(D, F)),
            "b1": _w((lambda *s: torch.randn(*s, dtype=torch.bfloat16) * 0.4)(F)),
            "w2": _w((lambda *s: torch.randn(*s, dtype=torch.bfloat16) * 0.05)(F, D)),
            "b2": _w((lambda *s: torch.randn(*s, dtype=torch.bfloat16) * 1.6)(D)),
        }
    _B_in = _B_setup()

    return {
        "A_x": _A_in["x"],
        "A_k_cache": _A_in["k_cache"],
        "A_v_cache": _A_in["v_cache"],
        "A_wq": _A_in["wq"],
        "A_wo": _A_in["wo"],
        "B_x": _B_in["x"],
        "B_w1": _B_in["w1"],
        "B_b1": _B_in["b1"],
        "B_w2": _B_in["w2"],
        "B_b2": _B_in["b2"],
    }

def reference(A_x, A_k_cache, A_v_cache, A_wq, A_wo, B_x, B_w1, B_b1, B_w2, B_b2):
    def _A_ref(x, k_cache, v_cache, wq, wo):
        B, Sq, D = x.shape
        Hq, Dh = 32, 128
        Hkv = k_cache.shape[1]
        rep = Hq // Hkv
        q = (lambda x, *d: x.permute(*d))((x @ wq).reshape(B, Sq, Hq, Dh), 0, 2, 1, 3)
        k = (lambda x, n, axis: torch.repeat_interleave(x, n, dim=axis))(k_cache, rep, axis=1)
        v = (lambda x, n, axis: torch.repeat_interleave(x, n, dim=axis))(v_cache, rep, axis=1)
        scores = torch.einsum("bhqd,bhkd->bhqk", q, k) * (Dh ** -0.5)
        p = _softmax(scores, axis=-1)
        o = torch.einsum("bhqk,bhkd->bhqd", p, v)
        return (lambda x, *d: x.permute(*d))(o, 0, 2, 1, 3).reshape(B, Sq, Hq * Dh) @ wo

    def _B_ref(x, w1, b1, w2, b2):
        h = torch.einsum("bsd,df->bsf", x, w1) + b1
        zero = torch.zeros_like(h)
        r = torch.where(h > zero, h, zero)
        h = r * r
        out = torch.einsum("bsf,fd->bsd", h, w2) + b2
        return out

    x = A_x
    xn = _layernorm(x, axis=-1)
    return x + _A_ref(xn, A_k_cache, A_v_cache, A_wq, A_wo) + _B_ref(xn, B_w1, B_b1, B_w2, B_b2)
```

```asm
; @launch grid=(256,1,1) block=(512,1,1) lds=24832
.amdgcn_target "amdgcn-amd-amdhsa--gfx950"
.text
.globl parallel_sum__gqa_block_cached__dense_activation_squared_relu__decode_kernel
.p2align 8
.type parallel_sum__gqa_block_cached__dense_activation_squared_relu__decode_kernel,@function
parallel_sum__gqa_block_cached__dense_activation_squared_relu__decode_kernel:
  s_cmp_ge_u32 s2, 256
  s_cbranch_scc1 L_end
  s_load_dwordx16 s[4:19], s[0:1], 0
  s_load_dwordx8 s[20:27], s[0:1], 64
  s_load_dwordx2 s[28:29], s[0:1], 96
  v_lshrrev_b32 v10, 6, v0
  v_and_b32 v1, 63, v0
  v_readfirstlane_b32 s30, v10
  v_lshrrev_b32 v2, 4, v1
  v_and_b32 v3, 15, v1
  s_lshr_b32 s31, s2, 5
  s_and_b32 s3, s2, 31
  s_mov_b32 s64, -1
  s_mov_b32 s65, 0
  s_cmp_ge_u32 s30, 4
  s_cbranch_scc1 L_helper
  s_lshl_b32 s50, s30, 10
  v_lshlrev_b32 v8, 4, v1
  v_add_u32 v8, s50, v8
  s_lshl_b32 s51, s2, 20
  s_mov_b32 s48, 0
  s_mov_b32 s42, 0x200000
  s_mov_b32 s43, 0x20000
  s_waitcnt lgkmcnt(0)
  s_add_u32 s40, s6, s51
  s_addc_u32 s41, s7, 0
  buffer_load_dwordx4 v[64:67], v8, s[40:43], 0 offen nt
  v_add_u32 v8, 4096, v8
  buffer_load_dwordx4 v[68:71], v8, s[40:43], 0 offen nt
  v_add_u32 v8, 4096, v8
  buffer_load_dwordx4 v[72:75], v8, s[40:43], 0 offen nt
  v_add_u32 v8, 4096, v8
  buffer_load_dwordx4 v[76:79], v8, s[40:43], 0 offen nt
  v_add_u32 v8, 4096, v8
  buffer_load_dwordx4 v[80:83], v8, s[40:43], 0 offen nt
  v_add_u32 v8, 4096, v8
  buffer_load_dwordx4 v[84:87], v8, s[40:43], 0 offen nt
  v_add_u32 v8, 4096, v8
  s_add_u32 s36, s8, s51
  s_addc_u32 s37, s9, 0
  s_sub_u32 s36, s36, 0x100000
  s_subb_u32 s37, s37, 0
  v_and_b32 v10, 1, v3
  v_lshlrev_b32 v10, 4, v10
  v_mov_b32 v11, 0xffff
  v_lshlrev_b32 v11, v10, v11
  v_lshrrev_b32 v12, 1, v3
  v_cmp_eq_u32 vcc, 0, v12
  s_nop 1
  v_cndmask_b32 v4, 0, v11, vcc
  v_cmp_eq_u32 vcc, 1, v12
  s_nop 1
  v_cndmask_b32 v5, 0, v11, vcc
  v_cmp_eq_u32 vcc, 2, v12
  s_nop 1
  v_cndmask_b32 v6, 0, v11, vcc
  v_cmp_eq_u32 vcc, 3, v12
  s_nop 1
  v_cndmask_b32 v7, 0, v11, vcc
  v_and_b32 v10, 2, v3
  v_cmp_ne_u32 s[58:59], 0, v10
  v_and_b32 v10, 1, v3
  v_cmp_ne_u32 s[60:61], 0, v10
  v_mov_b32 v48, 0xff800000
  v_mov_b32 v49, 0
  s_lshl_b32 s50, s30, 12
  s_add_u32 s50, s50, 8192
  v_lshlrev_b32 v52, 2, v1
  v_add_u32 v52, s50, v52
  v_lshlrev_b32 v10, 5, v3
  v_mov_b32 v24, 0
  v_mov_b32 v25, 0
  v_mov_b32 v26, 0
  v_mov_b32 v27, 0
  s_mov_b32 s49, 0
  s_mov_b32 s53, 0x3db504f3
  s_waitcnt vmcnt(5)
  buffer_load_dwordx4 v[88:91], v8, s[40:43], 0 offen nt
  v_add_u32 v8, 4096, v8
  s_waitcnt vmcnt(5)
  buffer_load_dwordx4 v[92:95], v8, s[40:43], 0 offen nt
  v_add_u32 v8, 4096, v8
  s_waitcnt vmcnt(5)
  buffer_load_dwordx4 v[96:99], v8, s[40:43], 0 offen nt
  v_add_u32 v8, 4096, v8
  s_waitcnt vmcnt(5)
  buffer_load_dwordx4 v[100:103], v8, s[40:43], 0 offen nt
  v_add_u32 v8, 4096, v8
  s_waitcnt vmcnt(5)
  buffer_load_dwordx4 v[104:107], v8, s[40:43], 0 offen nt
  v_add_u32 v8, 4096, v8
  s_waitcnt vmcnt(5)
  buffer_load_dwordx4 v[108:111], v8, s[40:43], 0 offen nt
  v_add_u32 v8, 4096, v8
  s_waitcnt vmcnt(5)
  buffer_load_dwordx4 v[112:115], v8, s[40:43], 0 offen nt
  v_add_u32 v8, 4096, v8
  s_waitcnt vmcnt(5)
  buffer_load_dwordx4 v[116:119], v8, s[40:43], 0 offen nt
  v_add_u32 v8, 4096, v8
  s_waitcnt vmcnt(5)
  buffer_load_dwordx4 v[120:123], v8, s[40:43], 0 offen nt
  v_add_u32 v8, 4096, v8
  s_waitcnt vmcnt(5)
  buffer_load_dwordx4 v[124:127], v8, s[40:43], 0 offen nt
  v_add_u32 v8, 4096, v8
  s_waitcnt vmcnt(5)
  buffer_load_dwordx4 v[128:131], v8, s[40:43], 0 offen nt
  v_add_u32 v8, 4096, v8
  s_waitcnt vmcnt(5)
  buffer_load_dwordx4 v[132:135], v8, s[40:43], 0 offen nt
  v_add_u32 v8, 4096, v8
  s_waitcnt vmcnt(5)
  buffer_load_dwordx4 v[136:139], v8, s[40:43], 0 offen nt
  v_add_u32 v8, 4096, v8
  s_waitcnt vmcnt(5)
  buffer_load_dwordx4 v[140:143], v8, s[40:43], 0 offen nt
  v_add_u32 v8, 4096, v8
  s_waitcnt vmcnt(5)
  buffer_load_dwordx4 v[144:147], v8, s[40:43], 0 offen nt
  v_add_u32 v8, 4096, v8
  s_waitcnt vmcnt(5)
  buffer_load_dwordx4 v[148:151], v8, s[40:43], 0 offen nt
  v_add_u32 v8, 4096, v8
  s_waitcnt vmcnt(5)
  buffer_load_dwordx4 v[152:155], v8, s[40:43], 0 offen nt
  v_add_u32 v8, 4096, v8
  s_waitcnt vmcnt(5)
  buffer_load_dwordx4 v[156:159], v8, s[40:43], 0 offen nt
  v_add_u32 v8, 4096, v8
  s_waitcnt vmcnt(5)
  buffer_load_dwordx4 v[160:163], v8, s[40:43], 0 offen nt
  v_add_u32 v8, 4096, v8
  s_waitcnt vmcnt(5)
  buffer_load_dwordx4 v[164:167], v8, s[40:43], 0 offen nt
  v_add_u32 v8, 4096, v8
  s_waitcnt vmcnt(5)
  buffer_load_dwordx4 v[168:171], v8, s[40:43], 0 offen nt
  v_add_u32 v8, 4096, v8
  s_waitcnt vmcnt(5)
  buffer_load_dwordx4 v[172:175], v8, s[40:43], 0 offen nt
  v_add_u32 v8, 4096, v8
  s_waitcnt vmcnt(5)
  buffer_load_dwordx4 v[176:179], v8, s[40:43], 0 offen nt
  v_add_u32 v8, 4096, v8
  s_waitcnt vmcnt(5)
  buffer_load_dwordx4 v[180:183], v8, s[40:43], 0 offen nt
  v_add_u32 v8, 4096, v8
  s_waitcnt vmcnt(5)
  buffer_load_dwordx4 v[184:187], v8, s[40:43], 0 offen nt
  v_add_u32 v8, 4096, v8
  s_waitcnt vmcnt(5)
  buffer_load_dwordx4 v[188:191], v8, s[40:43], 0 offen nt
  v_add_u32 v8, 4096, v8
  s_waitcnt vmcnt(5)
  buffer_load_dwordx4 v[192:195], v8, s[40:43], 0 offen nt
  v_add_u32 v8, 4096, v8
  s_waitcnt vmcnt(5)
  buffer_load_dwordx4 v[196:199], v8, s[40:43], 0 offen nt
  v_add_u32 v8, 4096, v8
  s_waitcnt vmcnt(5)
  buffer_load_dwordx4 v[200:203], v8, s[40:43], 0 offen nt
  v_add_u32 v8, 4096, v8
  s_waitcnt vmcnt(5)
  buffer_load_dwordx4 v[204:207], v8, s[40:43], 0 offen nt
  v_add_u32 v8, 4096, v8
  s_waitcnt vmcnt(5)
  buffer_load_dwordx4 v[208:211], v8, s[40:43], 0 offen nt
  v_add_u32 v8, 4096, v8
  s_waitcnt vmcnt(5)
  buffer_load_dwordx4 v[212:215], v8, s[40:43], 0 offen nt
  v_add_u32 v8, 4096, v8
  s_waitcnt vmcnt(5)
  buffer_load_dwordx4 v[216:219], v8, s[40:43], 0 offen nt
  v_add_u32 v8, 4096, v8
  s_waitcnt vmcnt(5)
  buffer_load_dwordx4 v[220:223], v8, s[40:43], 0 offen nt
  v_add_u32 v8, 4096, v8
  s_waitcnt vmcnt(5)
  buffer_load_dwordx4 v[224:227], v8, s[40:43], 0 offen nt
  v_add_u32 v8, 4096, v8
  s_waitcnt vmcnt(5)
  buffer_load_dwordx4 v[228:231], v8, s[40:43], 0 offen nt
  v_add_u32 v8, 4096, v8
  s_waitcnt vmcnt(5)
  buffer_load_dwordx4 v[232:235], v8, s[40:43], 0 offen nt
  v_add_u32 v8, 4096, v8
  s_waitcnt vmcnt(5)
  buffer_load_dwordx4 v[236:239], v8, s[40:43], 0 offen nt
  v_add_u32 v8, 4096, v8
  s_waitcnt vmcnt(5)
  buffer_load_dwordx4 v[240:243], v8, s[40:43], 0 offen nt
  v_add_u32 v8, 4096, v8
  s_waitcnt vmcnt(5)
  buffer_load_dwordx4 v[244:247], v8, s[40:43], 0 offen nt
  v_add_u32 v8, 4096, v8
  s_waitcnt vmcnt(5)
  buffer_load_dwordx4 v[248:251], v8, s[40:43], 0 offen nt
  v_add_u32 v8, 4096, v8
  s_waitcnt vmcnt(5)
  buffer_load_dwordx4 v[252:255], v8, s[40:43], 0 offen nt
  v_add_u32 v8, 4096, v8
  s_barrier
  ds_read_b128 v[32:35], v10 offset:0
  ds_read_b128 v[36:39], v10 offset:16
  ds_read_b128 v[40:43], v10 offset:512
  ds_read_b128 v[44:47], v10 offset:528
  ds_read_b128 v[16:19], v10 offset:1024
  ds_read_b128 v[20:23], v10 offset:1040
  ds_read_b128 v[56:59], v10 offset:1536
  ds_read_b128 v[60:63], v10 offset:1552
  s_waitcnt lgkmcnt(4)
  v_add_f32 v32, v32, v40
  v_add_f32 v33, v33, v41
  v_add_f32 v34, v34, v42
  v_add_f32 v35, v35, v43
  v_add_f32 v36, v36, v44
  v_add_f32 v37, v37, v45
  v_add_f32 v38, v38, v46
  v_add_f32 v39, v39, v47
  s_waitcnt lgkmcnt(0)
  v_add_f32 v16, v16, v56
  v_add_f32 v17, v17, v57
  v_add_f32 v18, v18, v58
  v_add_f32 v19, v19, v59
  v_add_f32 v20, v20, v60
  v_add_f32 v21, v21, v61
  v_add_f32 v22, v22, v62
  v_add_f32 v23, v23, v63
  v_add_f32 v32, v32, v16
  v_add_f32 v33, v33, v17
  v_add_f32 v34, v34, v18
  v_add_f32 v35, v35, v19
  v_add_f32 v36, v36, v20
  v_add_f32 v37, v37, v21
  v_add_f32 v38, v38, v22
  v_add_f32 v39, v39, v23
  v_cvt_pk_bf16_f32 v28, v32, v33
  v_cvt_pk_bf16_f32 v29, v34, v35
  v_cvt_pk_bf16_f32 v30, v36, v37
  v_cvt_pk_bf16_f32 v31, v38, v39
L_kloop:
  s_cmp_eq_u32 s49, 13
  s_cselect_b32 s40, s36, s40
  s_cselect_b32 s41, s37, s41
  s_add_u32 s49, s49, 1
  v_dot2_f32_bf16 v32, v64, v28, 0
  v_dot2_f32_bf16 v32, v65, v29, v32
  v_dot2_f32_bf16 v32, v66, v30, v32
  v_dot2_f32_bf16 v32, v67, v31, v32
  s_waitcnt vmcnt(4)
  buffer_load_dwordx4 v[64:67], v8, s[40:43], 0 offen nt
  v_add_u32 v8, 4096, v8
  v_dot2_f32_bf16 v33, v68, v28, 0
  v_dot2_f32_bf16 v33, v69, v29, v33
  v_dot2_f32_bf16 v33, v70, v30, v33
  v_dot2_f32_bf16 v33, v71, v31, v33
  s_waitcnt vmcnt(4)
  buffer_load_dwordx4 v[68:71], v8, s[40:43], 0 offen nt
  v_add_u32 v8, 4096, v8
  v_dot2_f32_bf16 v34, v72, v28, 0
  v_dot2_f32_bf16 v34, v73, v29, v34
  v_dot2_f32_bf16 v34, v74, v30, v34
  v_dot2_f32_bf16 v34, v75, v31, v34
  s_waitcnt vmcnt(4)
  buffer_load_dwordx4 v[72:75], v8, s[40:43], 0 offen nt
  v_add_u32 v8, 4096, v8
  v_dot2_f32_bf16 v35, v76, v28, 0
  v_dot2_f32_bf16 v35, v77, v29, v35
  v_dot2_f32_bf16 v35, v78, v30, v35
  v_dot2_f32_bf16 v35, v79, v31, v35
  s_waitcnt vmcnt(4)
  buffer_load_dwordx4 v[76:79], v8, s[40:43], 0 offen nt
  v_add_u32 v8, 4096, v8
  v_dot2_f32_bf16 v36, v80, v28, 0
  v_dot2_f32_bf16 v36, v81, v29, v36
  v_dot2_f32_bf16 v36, v82, v30, v36
  v_dot2_f32_bf16 v36, v83, v31, v36
  s_waitcnt vmcnt(4)
  buffer_load_dwordx4 v[80:83], v8, s[40:43], 0 offen nt
  v_add_u32 v8, 4096, v8
  v_dot2_f32_bf16 v37, v84, v28, 0
  v_dot2_f32_bf16 v37, v85, v29, v37
  v_dot2_f32_bf16 v37, v86, v30, v37
  v_dot2_f32_bf16 v37, v87, v31, v37
  s_waitcnt vmcnt(4)
  buffer_load_dwordx4 v[84:87], v8, s[40:43], 0 offen nt
  v_add_u32 v8, 4096, v8
  v_dot2_f32_bf16 v38, v88, v28, 0
  v_dot2_f32_bf16 v38, v89, v29, v38
  v_dot2_f32_bf16 v38, v90, v30, v38
  v_dot2_f32_bf16 v38, v91, v31, v38
  s_waitcnt vmcnt(4)
  buffer_load_dwordx4 v[88:91], v8, s[40:43], 0 offen nt
  v_add_u32 v8, 4096, v8
  v_dot2_f32_bf16 v39, v92, v28, 0
  v_dot2_f32_bf16 v39, v93, v29, v39
  v_dot2_f32_bf16 v39, v94, v30, v39
  v_dot2_f32_bf16 v39, v95, v31, v39
  s_waitcnt vmcnt(4)
  buffer_load_dwordx4 v[92:95], v8, s[40:43], 0 offen nt
  v_add_u32 v8, 4096, v8
  v_dot2_f32_bf16 v40, v96, v28, 0
  v_dot2_f32_bf16 v40, v97, v29, v40
  v_dot2_f32_bf16 v40, v98, v30, v40
  v_dot2_f32_bf16 v40, v99, v31, v40
  s_waitcnt vmcnt(4)
  buffer_load_dwordx4 v[96:99], v8, s[40:43], 0 offen nt
  v_add_u32 v8, 4096, v8
  v_dot2_f32_bf16 v41, v100, v28, 0
  v_dot2_f32_bf16 v41, v101, v29, v41
  v_dot2_f32_bf16 v41, v102, v30, v41
  v_dot2_f32_bf16 v41, v103, v31, v41
  s_waitcnt vmcnt(4)
  buffer_load_dwordx4 v[100:103], v8, s[40:43], 0 offen nt
  v_add_u32 v8, 4096, v8
  v_dot2_f32_bf16 v42, v104, v28, 0
  v_dot2_f32_bf16 v42, v105, v29, v42
  v_dot2_f32_bf16 v42, v106, v30, v42
  v_dot2_f32_bf16 v42, v107, v31, v42
  s_waitcnt vmcnt(4)
  buffer_load_dwordx4 v[104:107], v8, s[40:43], 0 offen nt
  v_add_u32 v8, 4096, v8
  v_dot2_f32_bf16 v43, v108, v28, 0
  v_dot2_f32_bf16 v43, v109, v29, v43
  v_dot2_f32_bf16 v43, v110, v30, v43
  v_dot2_f32_bf16 v43, v111, v31, v43
  s_waitcnt vmcnt(4)
  buffer_load_dwordx4 v[108:111], v8, s[40:43], 0 offen nt
  v_add_u32 v8, 4096, v8
  v_dot2_f32_bf16 v44, v112, v28, 0
  v_dot2_f32_bf16 v44, v113, v29, v44
  v_dot2_f32_bf16 v44, v114, v30, v44
  v_dot2_f32_bf16 v44, v115, v31, v44
  s_waitcnt vmcnt(4)
  buffer_load_dwordx4 v[112:115], v8, s[40:43], 0 offen nt
  v_add_u32 v8, 4096, v8
  v_dot2_f32_bf16 v45, v116, v28, 0
  v_dot2_f32_bf16 v45, v117, v29, v45
  v_dot2_f32_bf16 v45, v118, v30, v45
  v_dot2_f32_bf16 v45, v119, v31, v45
  s_waitcnt vmcnt(4)
  buffer_load_dwordx4 v[116:119], v8, s[40:43], 0 offen nt
  v_add_u32 v8, 4096, v8
  v_dot2_f32_bf16 v46, v120, v28, 0
  v_dot2_f32_bf16 v46, v121, v29, v46
  v_dot2_f32_bf16 v46, v122, v30, v46
  v_dot2_f32_bf16 v46, v123, v31, v46
  s_waitcnt vmcnt(4)
  buffer_load_dwordx4 v[120:123], v8, s[40:43], 0 offen nt
  v_add_u32 v8, 4096, v8
  v_dot2_f32_bf16 v47, v124, v28, 0
  v_dot2_f32_bf16 v47, v125, v29, v47
  v_dot2_f32_bf16 v47, v126, v30, v47
  v_dot2_f32_bf16 v47, v127, v31, v47
  s_waitcnt vmcnt(4)
  buffer_load_dwordx4 v[124:127], v8, s[40:43], 0 offen nt
  v_add_u32 v8, 4096, v8
  s_nop 1
  v_add_f32_dpp v32, v32, v32 row_ror:8 row_mask:0xf bank_mask:0x3
  v_add_f32_dpp v32, v40, v40 row_ror:8 row_mask:0xf bank_mask:0xc
  v_add_f32_dpp v33, v33, v33 row_ror:8 row_mask:0xf bank_mask:0x3
  v_add_f32_dpp v33, v41, v41 row_ror:8 row_mask:0xf bank_mask:0xc
  v_add_f32_dpp v34, v34, v34 row_ror:8 row_mask:0xf bank_mask:0x3
  v_add_f32_dpp v34, v42, v42 row_ror:8 row_mask:0xf bank_mask:0xc
  v_add_f32_dpp v35, v35, v35 row_ror:8 row_mask:0xf bank_mask:0x3
  v_add_f32_dpp v35, v43, v43 row_ror:8 row_mask:0xf bank_mask:0xc
  v_add_f32_dpp v36, v36, v36 row_ror:8 row_mask:0xf bank_mask:0x3
  v_add_f32_dpp v36, v44, v44 row_ror:8 row_mask:0xf bank_mask:0xc
  v_add_f32_dpp v37, v37, v37 row_ror:8 row_mask:0xf bank_mask:0x3
  v_add_f32_dpp v37, v45, v45 row_ror:8 row_mask:0xf bank_mask:0xc
  v_add_f32_dpp v38, v38, v38 row_ror:8 row_mask:0xf bank_mask:0x3
  v_add_f32_dpp v38, v46, v46 row_ror:8 row_mask:0xf bank_mask:0xc
  v_add_f32_dpp v39, v39, v39 row_ror:8 row_mask:0xf bank_mask:0x3
  v_add_f32_dpp v39, v47, v47 row_ror:8 row_mask:0xf bank_mask:0xc
  v_add_f32_dpp v32, v32, v32 row_half_mirror row_mask:0xf bank_mask:0x5
  v_add_f32_dpp v32, v36, v36 row_half_mirror row_mask:0xf bank_mask:0xa
  v_add_f32_dpp v33, v33, v33 row_half_mirror row_mask:0xf bank_mask:0x5
  v_add_f32_dpp v33, v37, v37 row_half_mirror row_mask:0xf bank_mask:0xa
  v_add_f32_dpp v34, v34, v34 row_half_mirror row_mask:0xf bank_mask:0x5
  v_add_f32_dpp v34, v38, v38 row_half_mirror row_mask:0xf bank_mask:0xa
  v_add_f32_dpp v35, v35, v35 row_half_mirror row_mask:0xf bank_mask:0x5
  v_add_f32_dpp v35, v39, v39 row_half_mirror row_mask:0xf bank_mask:0xa
  v_add_f32_dpp v32, v32, v32 quad_perm:[2,3,0,1] row_mask:0xf bank_mask:0xf
  v_add_f32_dpp v33, v33, v33 quad_perm:[2,3,0,1] row_mask:0xf bank_mask:0xf
  v_add_f32_dpp v34, v34, v34 quad_perm:[2,3,0,1] row_mask:0xf bank_mask:0xf
  v_add_f32_dpp v35, v35, v35 quad_perm:[2,3,0,1] row_mask:0xf bank_mask:0xf
  v_cndmask_b32 v32, v32, v34, s[58:59]
  v_cndmask_b32 v33, v33, v35, s[58:59]
  s_nop 1
  v_add_f32_dpp v32, v32, v32 quad_perm:[1,0,3,2] row_mask:0xf bank_mask:0xf
  v_add_f32_dpp v33, v33, v33 quad_perm:[1,0,3,2] row_mask:0xf bank_mask:0xf
  v_cndmask_b32 v32, v32, v33, s[60:61]
  v_cvt_pk_bf16_f32 v32, v32, v32
  v_lshlrev_b32 v32, 16, v32
  v_mul_f32 v32, s53, v32
  v_cvt_pk_bf16_f32 v32, v32, v32
  v_lshlrev_b32 v51, 16, v32
  v_max_f32 v48, v48, v51
  ds_write_b32 v52, v51 offset:0
  s_cmp_eq_u32 s49, 13
  s_cselect_b32 s40, s36, s40
  s_cselect_b32 s41, s37, s41
  s_add_u32 s49, s49, 1
  v_dot2_f32_bf16 v32, v128, v28, 0
  v_dot2_f32_bf16 v32, v129, v29, v32
  v_dot2_f32_bf16 v32, v130, v30, v32
  v_dot2_f32_bf16 v32, v131, v31, v32
  s_waitcnt vmcnt(4)
  buffer_load_dwordx4 v[128:131], v8, s[40:43], 0 offen nt
  v_add_u32 v8, 4096, v8
  v_dot2_f32_bf16 v33, v132, v28, 0
  v_dot2_f32_bf16 v33, v133, v29, v33
  v_dot2_f32_bf16 v33, v134, v30, v33
  v_dot2_f32_bf16 v33, v135, v31, v33
  s_waitcnt vmcnt(4)
  buffer_load_dwordx4 v[132:135], v8, s[40:43], 0 offen nt
  v_add_u32 v8, 4096, v8
  v_dot2_f32_bf16 v34, v136, v28, 0
  v_dot2_f32_bf16 v34, v137, v29, v34
  v_dot2_f32_bf16 v34, v138, v30, v34
  v_dot2_f32_bf16 v34, v139, v31, v34
  s_waitcnt vmcnt(4)
  buffer_load_dwordx4 v[136:139], v8, s[40:43], 0 offen nt
  v_add_u32 v8, 4096, v8
  v_dot2_f32_bf16 v35, v140, v28, 0
  v_dot2_f32_bf16 v35, v141, v29, v35
  v_dot2_f32_bf16 v35, v142, v30, v35
  v_dot2_f32_bf16 v35, v143, v31, v35
  s_waitcnt vmcnt(4)
  buffer_load_dwordx4 v[140:143], v8, s[40:43], 0 offen nt
  v_add_u32 v8, 4096, v8
  v_dot2_f32_bf16 v36, v144, v28, 0
  v_dot2_f32_bf16 v36, v145, v29, v36
  v_dot2_f32_bf16 v36, v146, v30, v36
  v_dot2_f32_bf16 v36, v147, v31, v36
  s_waitcnt vmcnt(4)
  buffer_load_dwordx4 v[144:147], v8, s[40:43], 0 offen nt
  v_add_u32 v8, 4096, v8
  v_dot2_f32_bf16 v37, v148, v28, 0
  v_dot2_f32_bf16 v37, v149, v29, v37
  v_dot2_f32_bf16 v37, v150, v30, v37
  v_dot2_f32_bf16 v37, v151, v31, v37
  s_waitcnt vmcnt(4)
  buffer_load_dwordx4 v[148:151], v8, s[40:43], 0 offen nt
  v_add_u32 v8, 4096, v8
  v_dot2_f32_bf16 v38, v152, v28, 0
  v_dot2_f32_bf16 v38, v153, v29, v38
  v_dot2_f32_bf16 v38, v154, v30, v38
  v_dot2_f32_bf16 v38, v155, v31, v38
  s_waitcnt vmcnt(4)
  buffer_load_dwordx4 v[152:155], v8, s[40:43], 0 offen nt
  v_add_u32 v8, 4096, v8
  v_dot2_f32_bf16 v39, v156, v28, 0
  v_dot2_f32_bf16 v39, v157, v29, v39
  v_dot2_f32_bf16 v39, v158, v30, v39
  v_dot2_f32_bf16 v39, v159, v31, v39
  s_waitcnt vmcnt(4)
  buffer_load_dwordx4 v[156:159], v8, s[40:43], 0 offen nt
  v_add_u32 v8, 4096, v8
  v_dot2_f32_bf16 v40, v160, v28, 0
  v_dot2_f32_bf16 v40, v161, v29, v40
  v_dot2_f32_bf16 v40, v162, v30, v40
  v_dot2_f32_bf16 v40, v163, v31, v40
  s_waitcnt vmcnt(4)
  buffer_load_dwordx4 v[160:163], v8, s[40:43], 0 offen nt
  v_add_u32 v8, 4096, v8
  v_dot2_f32_bf16 v41, v164, v28, 0
  v_dot2_f32_bf16 v41, v165, v29, v41
  v_dot2_f32_bf16 v41, v166, v30, v41
  v_dot2_f32_bf16 v41, v167, v31, v41
  s_waitcnt vmcnt(4)
  buffer_load_dwordx4 v[164:167], v8, s[40:43], 0 offen nt
  v_add_u32 v8, 4096, v8
  v_dot2_f32_bf16 v42, v168, v28, 0
  v_dot2_f32_bf16 v42, v169, v29, v42
  v_dot2_f32_bf16 v42, v170, v30, v42
  v_dot2_f32_bf16 v42, v171, v31, v42
  s_waitcnt vmcnt(4)
  buffer_load_dwordx4 v[168:171], v8, s[40:43], 0 offen nt
  v_add_u32 v8, 4096, v8
  v_dot2_f32_bf16 v43, v172, v28, 0
  v_dot2_f32_bf16 v43, v173, v29, v43
  v_dot2_f32_bf16 v43, v174, v30, v43
  v_dot2_f32_bf16 v43, v175, v31, v43
  s_waitcnt vmcnt(4)
  buffer_load_dwordx4 v[172:175], v8, s[40:43], 0 offen nt
  v_add_u32 v8, 4096, v8
  v_dot2_f32_bf16 v44, v176, v28, 0
  v_dot2_f32_bf16 v44, v177, v29, v44
  v_dot2_f32_bf16 v44, v178, v30, v44
  v_dot2_f32_bf16 v44, v179, v31, v44
  s_waitcnt vmcnt(4)
  buffer_load_dwordx4 v[176:179], v8, s[40:43], 0 offen nt
  v_add_u32 v8, 4096, v8
  v_dot2_f32_bf16 v45, v180, v28, 0
  v_dot2_f32_bf16 v45, v181, v29, v45
  v_dot2_f32_bf16 v45, v182, v30, v45
  v_dot2_f32_bf16 v45, v183, v31, v45
  s_waitcnt vmcnt(4)
  buffer_load_dwordx4 v[180:183], v8, s[40:43], 0 offen nt
  v_add_u32 v8, 4096, v8
  v_dot2_f32_bf16 v46, v184, v28, 0
  v_dot2_f32_bf16 v46, v185, v29, v46
  v_dot2_f32_bf16 v46, v186, v30, v46
  v_dot2_f32_bf16 v46, v187, v31, v46
  s_waitcnt vmcnt(4)
  buffer_load_dwordx4 v[184:187], v8, s[40:43], 0 offen nt
  v_add_u32 v8, 4096, v8
  v_dot2_f32_bf16 v47, v188, v28, 0
  v_dot2_f32_bf16 v47, v189, v29, v47
  v_dot2_f32_bf16 v47, v190, v30, v47
  v_dot2_f32_bf16 v47, v191, v31, v47
  s_waitcnt vmcnt(4)
  buffer_load_dwordx4 v[188:191], v8, s[40:43], 0 offen nt
  v_add_u32 v8, 4096, v8
  s_nop 1
  v_add_f32_dpp v32, v32, v32 row_ror:8 row_mask:0xf bank_mask:0x3
  v_add_f32_dpp v32, v40, v40 row_ror:8 row_mask:0xf bank_mask:0xc
  v_add_f32_dpp v33, v33, v33 row_ror:8 row_mask:0xf bank_mask:0x3
  v_add_f32_dpp v33, v41, v41 row_ror:8 row_mask:0xf bank_mask:0xc
  v_add_f32_dpp v34, v34, v34 row_ror:8 row_mask:0xf bank_mask:0x3
  v_add_f32_dpp v34, v42, v42 row_ror:8 row_mask:0xf bank_mask:0xc
  v_add_f32_dpp v35, v35, v35 row_ror:8 row_mask:0xf bank_mask:0x3
  v_add_f32_dpp v35, v43, v43 row_ror:8 row_mask:0xf bank_mask:0xc
  v_add_f32_dpp v36, v36, v36 row_ror:8 row_mask:0xf bank_mask:0x3
  v_add_f32_dpp v36, v44, v44 row_ror:8 row_mask:0xf bank_mask:0xc
  v_add_f32_dpp v37, v37, v37 row_ror:8 row_mask:0xf bank_mask:0x3
  v_add_f32_dpp v37, v45, v45 row_ror:8 row_mask:0xf bank_mask:0xc
  v_add_f32_dpp v38, v38, v38 row_ror:8 row_mask:0xf bank_mask:0x3
  v_add_f32_dpp v38, v46, v46 row_ror:8 row_mask:0xf bank_mask:0xc
  v_add_f32_dpp v39, v39, v39 row_ror:8 row_mask:0xf bank_mask:0x3
  v_add_f32_dpp v39, v47, v47 row_ror:8 row_mask:0xf bank_mask:0xc
  v_add_f32_dpp v32, v32, v32 row_half_mirror row_mask:0xf bank_mask:0x5
  v_add_f32_dpp v32, v36, v36 row_half_mirror row_mask:0xf bank_mask:0xa
  v_add_f32_dpp v33, v33, v33 row_half_mirror row_mask:0xf bank_mask:0x5
  v_add_f32_dpp v33, v37, v37 row_half_mirror row_mask:0xf bank_mask:0xa
  v_add_f32_dpp v34, v34, v34 row_half_mirror row_mask:0xf bank_mask:0x5
  v_add_f32_dpp v34, v38, v38 row_half_mirror row_mask:0xf bank_mask:0xa
  v_add_f32_dpp v35, v35, v35 row_half_mirror row_mask:0xf bank_mask:0x5
  v_add_f32_dpp v35, v39, v39 row_half_mirror row_mask:0xf bank_mask:0xa
  v_add_f32_dpp v32, v32, v32 quad_perm:[2,3,0,1] row_mask:0xf bank_mask:0xf
  v_add_f32_dpp v33, v33, v33 quad_perm:[2,3,0,1] row_mask:0xf bank_mask:0xf
  v_add_f32_dpp v34, v34, v34 quad_perm:[2,3,0,1] row_mask:0xf bank_mask:0xf
  v_add_f32_dpp v35, v35, v35 quad_perm:[2,3,0,1] row_mask:0xf bank_mask:0xf
  v_cndmask_b32 v32, v32, v34, s[58:59]
  v_cndmask_b32 v33, v33, v35, s[58:59]
  s_nop 1
  v_add_f32_dpp v32, v32, v32 quad_perm:[1,0,3,2] row_mask:0xf bank_mask:0xf
  v_add_f32_dpp v33, v33, v33 quad_perm:[1,0,3,2] row_mask:0xf bank_mask:0xf
  v_cndmask_b32 v32, v32, v33, s[60:61]
  v_cvt_pk_bf16_f32 v32, v32, v32
  v_lshlrev_b32 v32, 16, v32
  v_mul_f32 v32, s53, v32
  v_cvt_pk_bf16_f32 v32, v32, v32
  v_lshlrev_b32 v51, 16, v32
  v_max_f32 v48, v48, v51
  ds_write_b32 v52, v51 offset:256
  s_cmp_eq_u32 s49, 13
  s_cselect_b32 s40, s36, s40
  s_cselect_b32 s41, s37, s41
  s_add_u32 s49, s49, 1
  v_dot2_f32_bf16 v32, v192, v28, 0
  v_dot2_f32_bf16 v32, v193, v29, v32
  v_dot2_f32_bf16 v32, v194, v30, v32
  v_dot2_f32_bf16 v32, v195, v31, v32
  s_waitcnt vmcnt(4)
  buffer_load_dwordx4 v[192:195], v8, s[40:43], 0 offen nt
  v_add_u32 v8, 4096, v8
  v_dot2_f32_bf16 v33, v196, v28, 0
  v_dot2_f32_bf16 v33, v197, v29, v33
  v_dot2_f32_bf16 v33, v198, v30, v33
  v_dot2_f32_bf16 v33, v199, v31, v33
  s_waitcnt vmcnt(4)
  buffer_load_dwordx4 v[196:199], v8, s[40:43], 0 offen nt
  v_add_u32 v8, 4096, v8
  v_dot2_f32_bf16 v34, v200, v28, 0
  v_dot2_f32_bf16 v34, v201, v29, v34
  v_dot2_f32_bf16 v34, v202, v30, v34
  v_dot2_f32_bf16 v34, v203, v31, v34
  s_waitcnt vmcnt(4)
  buffer_load_dwordx4 v[200:203], v8, s[40:43], 0 offen nt
  v_add_u32 v8, 4096, v8
  v_dot2_f32_bf16 v35, v204, v28, 0
  v_dot2_f32_bf16 v35, v205, v29, v35
  v_dot2_f32_bf16 v35, v206, v30, v35
  v_dot2_f32_bf16 v35, v207, v31, v35
  s_waitcnt vmcnt(4)
  buffer_load_dwordx4 v[204:207], v8, s[40:43], 0 offen nt
  v_add_u32 v8, 4096, v8
  v_dot2_f32_bf16 v36, v208, v28, 0
  v_dot2_f32_bf16 v36, v209, v29, v36
  v_dot2_f32_bf16 v36, v210, v30, v36
  v_dot2_f32_bf16 v36, v211, v31, v36
  s_waitcnt vmcnt(4)
  buffer_load_dwordx4 v[208:211], v8, s[40:43], 0 offen nt
  v_add_u32 v8, 4096, v8
  v_dot2_f32_bf16 v37, v212, v28, 0
  v_dot2_f32_bf16 v37, v213, v29, v37
  v_dot2_f32_bf16 v37, v214, v30, v37
  v_dot2_f32_bf16 v37, v215, v31, v37
  s_waitcnt vmcnt(4)
  buffer_load_dwordx4 v[212:215], v8, s[40:43], 0 offen nt
  v_add_u32 v8, 4096, v8
  v_dot2_f32_bf16 v38, v216, v28, 0
  v_dot2_f32_bf16 v38, v217, v29, v38
  v_dot2_f32_bf16 v38, v218, v30, v38
  v_dot2_f32_bf16 v38, v219, v31, v38
  s_waitcnt vmcnt(4)
  buffer_load_dwordx4 v[216:219], v8, s[40:43], 0 offen nt
  v_add_u32 v8, 4096, v8
  v_dot2_f32_bf16 v39, v220, v28, 0
  v_dot2_f32_bf16 v39, v221, v29, v39
  v_dot2_f32_bf16 v39, v222, v30, v39
  v_dot2_f32_bf16 v39, v223, v31, v39
  s_waitcnt vmcnt(4)
  buffer_load_dwordx4 v[220:223], v8, s[40:43], 0 offen nt
  v_add_u32 v8, 4096, v8
  v_dot2_f32_bf16 v40, v224, v28, 0
  v_dot2_f32_bf16 v40, v225, v29, v40
  v_dot2_f32_bf16 v40, v226, v30, v40
  v_dot2_f32_bf16 v40, v227, v31, v40
  s_waitcnt vmcnt(4)
  buffer_load_dwordx4 v[224:227], v8, s[40:43], 0 offen nt
  v_add_u32 v8, 4096, v8
  v_dot2_f32_bf16 v41, v228, v28, 0
  v_dot2_f32_bf16 v41, v229, v29, v41
  v_dot2_f32_bf16 v41, v230, v30, v41
  v_dot2_f32_bf16 v41, v231, v31, v41
  s_waitcnt vmcnt(4)
  buffer_load_dwordx4 v[228:231], v8, s[40:43], 0 offen nt
  v_add_u32 v8, 4096, v8
  v_dot2_f32_bf16 v42, v232, v28, 0
  v_dot2_f32_bf16 v42, v233, v29, v42
  v_dot2_f32_bf16 v42, v234, v30, v42
  v_dot2_f32_bf16 v42, v235, v31, v42
  s_waitcnt vmcnt(4)
  buffer_load_dwordx4 v[232:235], v8, s[40:43], 0 offen nt
  v_add_u32 v8, 4096, v8
  v_dot2_f32_bf16 v43, v236, v28, 0
  v_dot2_f32_bf16 v43, v237, v29, v43
  v_dot2_f32_bf16 v43, v238, v30, v43
  v_dot2_f32_bf16 v43, v239, v31, v43
  s_waitcnt vmcnt(4)
  buffer_load_dwordx4 v[236:239], v8, s[40:43], 0 offen nt
  v_add_u32 v8, 4096, v8
  v_dot2_f32_bf16 v44, v240, v28, 0
  v_dot2_f32_bf16 v44, v241, v29, v44
  v_dot2_f32_bf16 v44, v242, v30, v44
  v_dot2_f32_bf16 v44, v243, v31, v44
  s_waitcnt vmcnt(4)
  buffer_load_dwordx4 v[240:243], v8, s[40:43], 0 offen nt
  v_add_u32 v8, 4096, v8
  v_dot2_f32_bf16 v45, v244, v28, 0
  v_dot2_f32_bf16 v45, v245, v29, v45
  v_dot2_f32_bf16 v45, v246, v30, v45
  v_dot2_f32_bf16 v45, v247, v31, v45
  s_waitcnt vmcnt(4)
  buffer_load_dwordx4 v[244:247], v8, s[40:43], 0 offen nt
  v_add_u32 v8, 4096, v8
  v_dot2_f32_bf16 v46, v248, v28, 0
  v_dot2_f32_bf16 v46, v249, v29, v46
  v_dot2_f32_bf16 v46, v250, v30, v46
  v_dot2_f32_bf16 v46, v251, v31, v46
  s_waitcnt vmcnt(4)
  buffer_load_dwordx4 v[248:251], v8, s[40:43], 0 offen nt
  v_add_u32 v8, 4096, v8
  v_dot2_f32_bf16 v47, v252, v28, 0
  v_dot2_f32_bf16 v47, v253, v29, v47
  v_dot2_f32_bf16 v47, v254, v30, v47
  v_dot2_f32_bf16 v47, v255, v31, v47
  s_waitcnt vmcnt(4)
  buffer_load_dwordx4 v[252:255], v8, s[40:43], 0 offen nt
  v_add_u32 v8, 4096, v8
  s_nop 1
  v_add_f32_dpp v32, v32, v32 row_ror:8 row_mask:0xf bank_mask:0x3
  v_add_f32_dpp v32, v40, v40 row_ror:8 row_mask:0xf bank_mask:0xc
  v_add_f32_dpp v33, v33, v33 row_ror:8 row_mask:0xf bank_mask:0x3
  v_add_f32_dpp v33, v41, v41 row_ror:8 row_mask:0xf bank_mask:0xc
  v_add_f32_dpp v34, v34, v34 row_ror:8 row_mask:0xf bank_mask:0x3
  v_add_f32_dpp v34, v42, v42 row_ror:8 row_mask:0xf bank_mask:0xc
  v_add_f32_dpp v35, v35, v35 row_ror:8 row_mask:0xf bank_mask:0x3
  v_add_f32_dpp v35, v43, v43 row_ror:8 row_mask:0xf bank_mask:0xc
  v_add_f32_dpp v36, v36, v36 row_ror:8 row_mask:0xf bank_mask:0x3
  v_add_f32_dpp v36, v44, v44 row_ror:8 row_mask:0xf bank_mask:0xc
  v_add_f32_dpp v37, v37, v37 row_ror:8 row_mask:0xf bank_mask:0x3
  v_add_f32_dpp v37, v45, v45 row_ror:8 row_mask:0xf bank_mask:0xc
  v_add_f32_dpp v38, v38, v38 row_ror:8 row_mask:0xf bank_mask:0x3
  v_add_f32_dpp v38, v46, v46 row_ror:8 row_mask:0xf bank_mask:0xc
  v_add_f32_dpp v39, v39, v39 row_ror:8 row_mask:0xf bank_mask:0x3
  v_add_f32_dpp v39, v47, v47 row_ror:8 row_mask:0xf bank_mask:0xc
  v_add_f32_dpp v32, v32, v32 row_half_mirror row_mask:0xf bank_mask:0x5
  v_add_f32_dpp v32, v36, v36 row_half_mirror row_mask:0xf bank_mask:0xa
  v_add_f32_dpp v33, v33, v33 row_half_mirror row_mask:0xf bank_mask:0x5
  v_add_f32_dpp v33, v37, v37 row_half_mirror row_mask:0xf bank_mask:0xa
  v_add_f32_dpp v34, v34, v34 row_half_mirror row_mask:0xf bank_mask:0x5
  v_add_f32_dpp v34, v38, v38 row_half_mirror row_mask:0xf bank_mask:0xa
  v_add_f32_dpp v35, v35, v35 row_half_mirror row_mask:0xf bank_mask:0x5
  v_add_f32_dpp v35, v39, v39 row_half_mirror row_mask:0xf bank_mask:0xa
  v_add_f32_dpp v32, v32, v32 quad_perm:[2,3,0,1] row_mask:0xf bank_mask:0xf
  v_add_f32_dpp v33, v33, v33 quad_perm:[2,3,0,1] row_mask:0xf bank_mask:0xf
  v_add_f32_dpp v34, v34, v34 quad_perm:[2,3,0,1] row_mask:0xf bank_mask:0xf
  v_add_f32_dpp v35, v35, v35 quad_perm:[2,3,0,1] row_mask:0xf bank_mask:0xf
  v_cndmask_b32 v32, v32, v34, s[58:59]
  v_cndmask_b32 v33, v33, v35, s[58:59]
  s_nop 1
  v_add_f32_dpp v32, v32, v32 quad_perm:[1,0,3,2] row_mask:0xf bank_mask:0xf
  v_add_f32_dpp v33, v33, v33 quad_perm:[1,0,3,2] row_mask:0xf bank_mask:0xf
  v_cndmask_b32 v32, v32, v33, s[60:61]
  v_cvt_pk_bf16_f32 v32, v32, v32
  v_lshlrev_b32 v32, 16, v32
  v_mul_f32 v32, s53, v32
  v_cvt_pk_bf16_f32 v32, v32, v32
  v_lshlrev_b32 v51, 16, v32
  v_max_f32 v48, v48, v51
  ds_write_b32 v52, v51 offset:512
  v_add_u32 v52, 768, v52
  s_cmp_lt_u32 s49, 15
  s_cbranch_scc1 L_kloop
  s_cmp_eq_u32 s49, 13
  s_cselect_b32 s40, s36, s40
  s_cselect_b32 s41, s37, s41
  s_add_u32 s49, s49, 1
  v_dot2_f32_bf16 v32, v64, v28, 0
  v_dot2_f32_bf16 v32, v65, v29, v32
  v_dot2_f32_bf16 v32, v66, v30, v32
  v_dot2_f32_bf16 v32, v67, v31, v32
  s_waitcnt vmcnt(4)
  buffer_load_dwordx4 v[64:67], v8, s[40:43], 0 offen nt
  v_add_u32 v8, 4096, v8
  v_dot2_f32_bf16 v33, v68, v28, 0
  v_dot2_f32_bf16 v33, v69, v29, v33
  v_dot2_f32_bf16 v33, v70, v30, v33
  v_dot2_f32_bf16 v33, v71, v31, v33
  s_waitcnt vmcnt(4)
  buffer_load_dwordx4 v[68:71], v8, s[40:43], 0 offen nt
  v_add_u32 v8, 4096, v8
  v_dot2_f32_bf16 v34, v72, v28, 0
  v_dot2_f32_bf16 v34, v73, v29, v34
  v_dot2_f32_bf16 v34, v74, v30, v34
  v_dot2_f32_bf16 v34, v75, v31, v34
  s_waitcnt vmcnt(4)
  buffer_load_dwordx4 v[72:75], v8, s[40:43], 0 offen nt
  v_add_u32 v8, 4096, v8
  v_dot2_f32_bf16 v35, v76, v28, 0
  v_dot2_f32_bf16 v35, v77, v29, v35
  v_dot2_f32_bf16 v35, v78, v30, v35
  v_dot2_f32_bf16 v35, v79, v31, v35
  s_waitcnt vmcnt(4)
  buffer_load_dwordx4 v[76:79], v8, s[40:43], 0 offen nt
  v_add_u32 v8, 4096, v8
  v_dot2_f32_bf16 v36, v80, v28, 0
  v_dot2_f32_bf16 v36, v81, v29, v36
  v_dot2_f32_bf16 v36, v82, v30, v36
  v_dot2_f32_bf16 v36, v83, v31, v36
  s_waitcnt vmcnt(4)
  buffer_load_dwordx4 v[80:83], v8, s[40:43], 0 offen nt
  v_add_u32 v8, 4096, v8
  v_dot2_f32_bf16 v37, v84, v28, 0
  v_dot2_f32_bf16 v37, v85, v29, v37
  v_dot2_f32_bf16 v37, v86, v30, v37
  v_dot2_f32_bf16 v37, v87, v31, v37
  s_waitcnt vmcnt(4)
  buffer_load_dwordx4 v[84:87], v8, s[40:43], 0 offen nt
  v_add_u32 v8, 4096, v8
  v_dot2_f32_bf16 v38, v88, v28, 0
  v_dot2_f32_bf16 v38, v89, v29, v38
  v_dot2_f32_bf16 v38, v90, v30, v38
  v_dot2_f32_bf16 v38, v91, v31, v38
  s_waitcnt vmcnt(4)
  buffer_load_dwordx4 v[88:91], v8, s[40:43], 0 offen nt
  v_add_u32 v8, 4096, v8
  v_dot2_f32_bf16 v39, v92, v28, 0
  v_dot2_f32_bf16 v39, v93, v29, v39
  v_dot2_f32_bf16 v39, v94, v30, v39
  v_dot2_f32_bf16 v39, v95, v31, v39
  s_waitcnt vmcnt(4)
  buffer_load_dwordx4 v[92:95], v8, s[40:43], 0 offen nt
  v_add_u32 v8, 4096, v8
  v_dot2_f32_bf16 v40, v96, v28, 0
  v_dot2_f32_bf16 v40, v97, v29, v40
  v_dot2_f32_bf16 v40, v98, v30, v40
  v_dot2_f32_bf16 v40, v99, v31, v40
  s_waitcnt vmcnt(4)
  buffer_load_dwordx4 v[96:99], v8, s[40:43], 0 offen nt
  v_add_u32 v8, 4096, v8
  v_dot2_f32_bf16 v41, v100, v28, 0
  v_dot2_f32_bf16 v41, v101, v29, v41
  v_dot2_f32_bf16 v41, v102, v30, v41
  v_dot2_f32_bf16 v41, v103, v31, v41
  s_waitcnt vmcnt(4)
  buffer_load_dwordx4 v[100:103], v8, s[40:43], 0 offen nt
  v_add_u32 v8, 4096, v8
  v_dot2_f32_bf16 v42, v104, v28, 0
  v_dot2_f32_bf16 v42, v105, v29, v42
  v_dot2_f32_bf16 v42, v106, v30, v42
  v_dot2_f32_bf16 v42, v107, v31, v42
  s_waitcnt vmcnt(4)
  buffer_load_dwordx4 v[104:107], v8, s[40:43], 0 offen nt
  v_add_u32 v8, 4096, v8
  v_dot2_f32_bf16 v43, v108, v28, 0
  v_dot2_f32_bf16 v43, v109, v29, v43
  v_dot2_f32_bf16 v43, v110, v30, v43
  v_dot2_f32_bf16 v43, v111, v31, v43
  s_waitcnt vmcnt(4)
  buffer_load_dwordx4 v[108:111], v8, s[40:43], 0 offen nt
  v_add_u32 v8, 4096, v8
  v_dot2_f32_bf16 v44, v112, v28, 0
  v_dot2_f32_bf16 v44, v113, v29, v44
  v_dot2_f32_bf16 v44, v114, v30, v44
  v_dot2_f32_bf16 v44, v115, v31, v44
  s_waitcnt vmcnt(4)
  buffer_load_dwordx4 v[112:115], v8, s[40:43], 0 offen nt
  v_add_u32 v8, 4096, v8
  v_dot2_f32_bf16 v45, v116, v28, 0
  v_dot2_f32_bf16 v45, v117, v29, v45
  v_dot2_f32_bf16 v45, v118, v30, v45
  v_dot2_f32_bf16 v45, v119, v31, v45
  s_waitcnt vmcnt(4)
  buffer_load_dwordx4 v[116:119], v8, s[40:43], 0 offen nt
  v_add_u32 v8, 4096, v8
  v_dot2_f32_bf16 v46, v120, v28, 0
  v_dot2_f32_bf16 v46, v121, v29, v46
  v_dot2_f32_bf16 v46, v122, v30, v46
  v_dot2_f32_bf16 v46, v123, v31, v46
  s_waitcnt vmcnt(4)
  buffer_load_dwordx4 v[120:123], v8, s[40:43], 0 offen nt
  v_add_u32 v8, 4096, v8
  v_dot2_f32_bf16 v47, v124, v28, 0
  v_dot2_f32_bf16 v47, v125, v29, v47
  v_dot2_f32_bf16 v47, v126, v30, v47
  v_dot2_f32_bf16 v47, v127, v31, v47
  s_waitcnt vmcnt(4)
  buffer_load_dwordx4 v[124:127], v8, s[40:43], 0 offen nt
  v_add_u32 v8, 4096, v8
  s_nop 1
  v_add_f32_dpp v32, v32, v32 row_ror:8 row_mask:0xf bank_mask:0x3
  v_add_f32_dpp v32, v40, v40 row_ror:8 row_mask:0xf bank_mask:0xc
  v_add_f32_dpp v33, v33, v33 row_ror:8 row_mask:0xf bank_mask:0x3
  v_add_f32_dpp v33, v41, v41 row_ror:8 row_mask:0xf bank_mask:0xc
  v_add_f32_dpp v34, v34, v34 row_ror:8 row_mask:0xf bank_mask:0x3
  v_add_f32_dpp v34, v42, v42 row_ror:8 row_mask:0xf bank_mask:0xc
  v_add_f32_dpp v35, v35, v35 row_ror:8 row_mask:0xf bank_mask:0x3
  v_add_f32_dpp v35, v43, v43 row_ror:8 row_mask:0xf bank_mask:0xc
  v_add_f32_dpp v36, v36, v36 row_ror:8 row_mask:0xf bank_mask:0x3
  v_add_f32_dpp v36, v44, v44 row_ror:8 row_mask:0xf bank_mask:0xc
  v_add_f32_dpp v37, v37, v37 row_ror:8 row_mask:0xf bank_mask:0x3
  v_add_f32_dpp v37, v45, v45 row_ror:8 row_mask:0xf bank_mask:0xc
  v_add_f32_dpp v38, v38, v38 row_ror:8 row_mask:0xf bank_mask:0x3
  v_add_f32_dpp v38, v46, v46 row_ror:8 row_mask:0xf bank_mask:0xc
  v_add_f32_dpp v39, v39, v39 row_ror:8 row_mask:0xf bank_mask:0x3
  v_add_f32_dpp v39, v47, v47 row_ror:8 row_mask:0xf bank_mask:0xc
  v_add_f32_dpp v32, v32, v32 row_half_mirror row_mask:0xf bank_mask:0x5
  v_add_f32_dpp v32, v36, v36 row_half_mirror row_mask:0xf bank_mask:0xa
  v_add_f32_dpp v33, v33, v33 row_half_mirror row_mask:0xf bank_mask:0x5
  v_add_f32_dpp v33, v37, v37 row_half_mirror row_mask:0xf bank_mask:0xa
  v_add_f32_dpp v34, v34, v34 row_half_mirror row_mask:0xf bank_mask:0x5
  v_add_f32_dpp v34, v38, v38 row_half_mirror row_mask:0xf bank_mask:0xa
  v_add_f32_dpp v35, v35, v35 row_half_mirror row_mask:0xf bank_mask:0x5
  v_add_f32_dpp v35, v39, v39 row_half_mirror row_mask:0xf bank_mask:0xa
  v_add_f32_dpp v32, v32, v32 quad_perm:[2,3,0,1] row_mask:0xf bank_mask:0xf
  v_add_f32_dpp v33, v33, v33 quad_perm:[2,3,0,1] row_mask:0xf bank_mask:0xf
  v_add_f32_dpp v34, v34, v34 quad_perm:[2,3,0,1] row_mask:0xf bank_mask:0xf
  v_add_f32_dpp v35, v35, v35 quad_perm:[2,3,0,1] row_mask:0xf bank_mask:0xf
  v_cndmask_b32 v32, v32, v34, s[58:59]
  v_cndmask_b32 v33, v33, v35, s[58:59]
  s_nop 1
  v_add_f32_dpp v32, v32, v32 quad_perm:[1,0,3,2] row_mask:0xf bank_mask:0xf
  v_add_f32_dpp v33, v33, v33 quad_perm:[1,0,3,2] row_mask:0xf bank_mask:0xf
  v_cndmask_b32 v32, v32, v33, s[60:61]
  v_cvt_pk_bf16_f32 v32, v32, v32
  v_lshlrev_b32 v32, 16, v32
  v_mul_f32 v32, s53, v32
  v_cvt_pk_bf16_f32 v32, v32, v32
  v_lshlrev_b32 v51, 16, v32
  v_max_f32 v48, v48, v51
  ds_write_b32 v52, v51 offset:0
  v_subrev_u32 v52, 3840, v52
  s_nop 0
  v_max_f32_dpp v48, v48, v48 row_ror:8 row_mask:0xf bank_mask:0xf
  s_nop 1
  v_max_f32_dpp v48, v48, v48 row_ror:4 row_mask:0xf bank_mask:0xf
  s_nop 1
  v_max_f32_dpp v48, v48, v48 row_ror:2 row_mask:0xf bank_mask:0xf
  s_nop 1
  v_max_f32_dpp v48, v48, v48 row_ror:1 row_mask:0xf bank_mask:0xf
  s_nop 1
  v_max_f32_dpp v48, v48, v48 row_bcast:15 row_mask:0xa bank_mask:0xf
  s_nop 1
  v_max_f32_dpp v48, v48, v48 row_bcast:31 row_mask:0xc bank_mask:0xf
  s_waitcnt lgkmcnt(0)
  ds_read_b32 v51, v52
  v_readlane_b32 s54, v48, 63
  s_mov_b32 s53, 0x3fb8aa3b
  s_mov_b32 s49, 0
L_vloop:
  s_waitcnt lgkmcnt(0)
  v_subrev_f32 v10, s54, v51
  v_mul_f32 v10, s53, v10
  v_exp_f32 v10, v10
  ds_read_b32 v51, v52 offset:256
  v_add_f32 v49, v49, v10
  v_cvt_pk_bf16_f32 v50, v10, v10
  s_nop 1
  v_and_b32_dpp v16, v50, v4 row_newbcast:0 row_mask:0xf bank_mask:0xf
  v_and_b32_dpp v17, v50, v5 row_newbcast:0 row_mask:0xf bank_mask:0xf
  v_and_b32_dpp v18, v50, v6 row_newbcast:0 row_mask:0xf bank_mask:0xf
  v_and_b32_dpp v19, v50, v7 row_newbcast:0 row_mask:0xf bank_mask:0xf
  v_and_b32_dpp v20, v50, v4 row_newbcast:1 row_mask:0xf bank_mask:0xf
  v_and_b32_dpp v21, v50, v5 row_newbcast:1 row_mask:0xf bank_mask:0xf
  v_and_b32_dpp v22, v50, v6 row_newbcast:1 row_mask:0xf bank_mask:0xf
  v_and_b32_dpp v23, v50, v7 row_newbcast:1 row_mask:0xf bank_mask:0xf
  v_mfma_f32_16x16x32_bf16 v[24:27], v[16:19], v[128:131], v[24:27]
  s_waitcnt vmcnt(4)
  buffer_load_dwordx4 v[128:131], v8, s[40:43], 0 offen nt
  v_add_u32 v8, 4096, v8
  v_and_b32_dpp v16, v50, v4 row_newbcast:2 row_mask:0xf bank_mask:0xf
  v_and_b32_dpp v17, v50, v5 row_newbcast:2 row_mask:0xf bank_mask:0xf
  v_and_b32_dpp v18, v50, v6 row_newbcast:2 row_mask:0xf bank_mask:0xf
  v_and_b32_dpp v19, v50, v7 row_newbcast:2 row_mask:0xf bank_mask:0xf
  v_mfma_f32_16x16x32_bf16 v[24:27], v[20:23], v[132:135], v[24:27]
  s_waitcnt vmcnt(4)
  buffer_load_dwordx4 v[132:135], v8, s[40:43], 0 offen nt
  v_add_u32 v8, 4096, v8
  v_and_b32_dpp v20, v50, v4 row_newbcast:3 row_mask:0xf bank_mask:0xf
  v_and_b32_dpp v21, v50, v5 row_newbcast:3 row_mask:0xf bank_mask:0xf
  v_and_b32_dpp v22, v50, v6 row_newbcast:3 row_mask:0xf bank_mask:0xf
  v_and_b32_dpp v23, v50, v7 row_newbcast:3 row_mask:0xf bank_mask:0xf
  v_mfma_f32_16x16x32_bf16 v[24:27], v[16:19], v[136:139], v[24:27]
  s_waitcnt vmcnt(4)
  buffer_load_dwordx4 v[136:139], v8, s[40:43], 0 offen nt
  v_add_u32 v8, 4096, v8
  v_and_b32_dpp v16, v50, v4 row_newbcast:4 row_mask:0xf bank_mask:0xf
  v_and_b32_dpp v17, v50, v5 row_newbcast:4 row_mask:0xf bank_mask:0xf
  v_and_b32_dpp v18, v50, v6 row_newbcast:4 row_mask:0xf bank_mask:0xf
  v_and_b32_dpp v19, v50, v7 row_newbcast:4 row_mask:0xf bank_mask:0xf
  v_mfma_f32_16x16x32_bf16 v[24:27], v[20:23], v[140:143], v[24:27]
  s_waitcnt vmcnt(4)
  buffer_load_dwordx4 v[140:143], v8, s[40:43], 0 offen nt
  v_add_u32 v8, 4096, v8
  v_and_b32_dpp v20, v50, v4 row_newbcast:5 row_mask:0xf bank_mask:0xf
  v_and_b32_dpp v21, v50, v5 row_newbcast:5 row_mask:0xf bank_mask:0xf
  v_and_b32_dpp v22, v50, v6 row_newbcast:5 row_mask:0xf bank_mask:0xf
  v_and_b32_dpp v23, v50, v7 row_newbcast:5 row_mask:0xf bank_mask:0xf
  v_mfma_f32_16x16x32_bf16 v[24:27], v[16:19], v[144:147], v[24:27]
  s_waitcnt vmcnt(4)
  buffer_load_dwordx4 v[144:147], v8, s[40:43], 0 offen nt
  v_add_u32 v8, 4096, v8
  v_and_b32_dpp v16, v50, v4 row_newbcast:6 row_mask:0xf bank_mask:0xf
  v_and_b32_dpp v17, v50, v5 row_newbcast:6 row_mask:0xf bank_mask:0xf
  v_and_b32_dpp v18, v50, v6 row_newbcast:6 row_mask:0xf bank_mask:0xf
  v_and_b32_dpp v19, v50, v7 row_newbcast:6 row_mask:0xf bank_mask:0xf
  v_mfma_f32_16x16x32_bf16 v[24:27], v[20:23], v[148:151], v[24:27]
  s_waitcnt vmcnt(4)
  buffer_load_dwordx4 v[148:151], v8, s[40:43], 0 offen nt
  v_add_u32 v8, 4096, v8
  v_and_b32_dpp v20, v50, v4 row_newbcast:7 row_mask:0xf bank_mask:0xf
  v_and_b32_dpp v21, v50, v5 row_newbcast:7 row_mask:0xf bank_mask:0xf
  v_and_b32_dpp v22, v50, v6 row_newbcast:7 row_mask:0xf bank_mask:0xf
  v_and_b32_dpp v23, v50, v7 row_newbcast:7 row_mask:0xf bank_mask:0xf
  v_mfma_f32_16x16x32_bf16 v[24:27], v[16:19], v[152:155], v[24:27]
  s_waitcnt vmcnt(4)
  buffer_load_dwordx4 v[152:155], v8, s[40:43], 0 offen nt
  v_add_u32 v8, 4096, v8
  v_and_b32_dpp v16, v50, v4 row_newbcast:8 row_mask:0xf bank_mask:0xf
  v_and_b32_dpp v17, v50, v5 row_newbcast:8 row_mask:0xf bank_mask:0xf
  v_and_b32_dpp v18, v50, v6 row_newbcast:8 row_mask:0xf bank_mask:0xf
  v_and_b32_dpp v19, v50, v7 row_newbcast:8 row_mask:0xf bank_mask:0xf
  v_mfma_f32_16x16x32_bf16 v[24:27], v[20:23], v[156:159], v[24:27]
  s_waitcnt vmcnt(4)
  buffer_load_dwordx4 v[156:159], v8, s[40:43], 0 offen nt
  v_add_u32 v8, 4096, v8
  v_and_b32_dpp v20, v50, v4 row_newbcast:9 row_mask:0xf bank_mask:0xf
  v_and_b32_dpp v21, v50, v5 row_newbcast:9 row_mask:0xf bank_mask:0xf
  v_and_b32_dpp v22, v50, v6 row_newbcast:9 row_mask:0xf bank_mask:0xf
  v_and_b32_dpp v23, v50, v7 row_newbcast:9 row_mask:0xf bank_mask:0xf
  v_mfma_f32_16x16x32_bf16 v[24:27], v[16:19], v[160:163], v[24:27]
  s_waitcnt vmcnt(4)
  buffer_load_dwordx4 v[160:163], v8, s[40:43], 0 offen nt
  v_add_u32 v8, 4096, v8
  v_and_b32_dpp v16, v50, v4 row_newbcast:10 row_mask:0xf bank_mask:0xf
  v_and_b32_dpp v17, v50, v5 row_newbcast:10 row_mask:0xf bank_mask:0xf
  v_and_b32_dpp v18, v50, v6 row_newbcast:10 row_mask:0xf bank_mask:0xf
  v_and_b32_dpp v19, v50, v7 row_newbcast:10 row_mask:0xf bank_mask:0xf
  v_mfma_f32_16x16x32_bf16 v[24:27], v[20:23], v[164:167], v[24:27]
  s_waitcnt vmcnt(4)
  buffer_load_dwordx4 v[164:167], v8, s[40:43], 0 offen nt
  v_add_u32 v8, 4096, v8
  v_and_b32_dpp v20, v50, v4 row_newbcast:11 row_mask:0xf bank_mask:0xf
  v_and_b32_dpp v21, v50, v5 row_newbcast:11 row_mask:0xf bank_mask:0xf
  v_and_b32_dpp v22, v50, v6 row_newbcast:11 row_mask:0xf bank_mask:0xf
  v_and_b32_dpp v23, v50, v7 row_newbcast:11 row_mask:0xf bank_mask:0xf
  v_mfma_f32_16x16x32_bf16 v[24:27], v[16:19], v[168:171], v[24:27]
  s_waitcnt vmcnt(4)
  buffer_load_dwordx4 v[168:171], v8, s[40:43], 0 offen nt
  v_add_u32 v8, 4096, v8
  v_and_b32_dpp v16, v50, v4 row_newbcast:12 row_mask:0xf bank_mask:0xf
  v_and_b32_dpp v17, v50, v5 row_newbcast:12 row_mask:0xf bank_mask:0xf
  v_and_b32_dpp v18, v50, v6 row_newbcast:12 row_mask:0xf bank_mask:0xf
  v_and_b32_dpp v19, v50, v7 row_newbcast:12 row_mask:0xf bank_mask:0xf
  v_mfma_f32_16x16x32_bf16 v[24:27], v[20:23], v[172:175], v[24:27]
  s_waitcnt vmcnt(4)
  buffer_load_dwordx4 v[172:175], v8, s[40:43], 0 offen nt
  v_add_u32 v8, 4096, v8
  v_and_b32_dpp v20, v50, v4 row_newbcast:13 row_mask:0xf bank_mask:0xf
  v_and_b32_dpp v21, v50, v5 row_newbcast:13 row_mask:0xf bank_mask:0xf
  v_and_b32_dpp v22, v50, v6 row_newbcast:13 row_mask:0xf bank_mask:0xf
  v_and_b32_dpp v23, v50, v7 row_newbcast:13 row_mask:0xf bank_mask:0xf
  v_mfma_f32_16x16x32_bf16 v[24:27], v[16:19], v[176:179], v[24:27]
  s_waitcnt vmcnt(4)
  buffer_load_dwordx4 v[176:179], v8, s[40:43], 0 offen nt
  v_add_u32 v8, 4096, v8
  v_and_b32_dpp v16, v50, v4 row_newbcast:14 row_mask:0xf bank_mask:0xf
  v_and_b32_dpp v17, v50, v5 row_newbcast:14 row_mask:0xf bank_mask:0xf
  v_and_b32_dpp v18, v50, v6 row_newbcast:14 row_mask:0xf bank_mask:0xf
  v_and_b32_dpp v19, v50, v7 row_newbcast:14 row_mask:0xf bank_mask:0xf
  v_mfma_f32_16x16x32_bf16 v[24:27], v[20:23], v[180:183], v[24:27]
  s_waitcnt vmcnt(4)
  buffer_load_dwordx4 v[180:183], v8, s[40:43], 0 offen nt
  v_add_u32 v8, 4096, v8
  v_and_b32_dpp v20, v50, v4 row_newbcast:15 row_mask:0xf bank_mask:0xf
  v_and_b32_dpp v21, v50, v5 row_newbcast:15 row_mask:0xf bank_mask:0xf
  v_and_b32_dpp v22, v50, v6 row_newbcast:15 row_mask:0xf bank_mask:0xf
  v_and_b32_dpp v23, v50, v7 row_newbcast:15 row_mask:0xf bank_mask:0xf
  v_mfma_f32_16x16x32_bf16 v[24:27], v[16:19], v[184:187], v[24:27]
  s_waitcnt vmcnt(4)
  buffer_load_dwordx4 v[184:187], v8, s[40:43], 0 offen nt
  v_add_u32 v8, 4096, v8
  s_nop 0
  v_mfma_f32_16x16x32_bf16 v[24:27], v[20:23], v[188:191], v[24:27]
  s_waitcnt vmcnt(4)
  buffer_load_dwordx4 v[188:191], v8, s[40:43], 0 offen nt
  v_add_u32 v8, 4096, v8
  s_waitcnt lgkmcnt(0)
  v_subrev_f32 v10, s54, v51
  v_mul_f32 v10, s53, v10
  v_exp_f32 v10, v10
  ds_read_b32 v51, v52 offset:512
  v_add_f32 v49, v49, v10
  v_cvt_pk_bf16_f32 v50, v10, v10
  s_nop 1
  v_and_b32_dpp v16, v50, v4 row_newbcast:0 row_mask:0xf bank_mask:0xf
  v_and_b32_dpp v17, v50, v5 row_newbcast:0 row_mask:0xf bank_mask:0xf
  v_and_b32_dpp v18, v50, v6 row_newbcast:0 row_mask:0xf bank_mask:0xf
  v_and_b32_dpp v19, v50, v7 row_newbcast:0 row_mask:0xf bank_mask:0xf
  v_and_b32_dpp v20, v50, v4 row_newbcast:1 row_mask:0xf bank_mask:0xf
  v_and_b32_dpp v21, v50, v5 row_newbcast:1 row_mask:0xf bank_mask:0xf
  v_and_b32_dpp v22, v50, v6 row_newbcast:1 row_mask:0xf bank_mask:0xf
  v_and_b32_dpp v23, v50, v7 row_newbcast:1 row_mask:0xf bank_mask:0xf
  v_mfma_f32_16x16x32_bf16 v[24:27], v[16:19], v[192:195], v[24:27]
  s_waitcnt vmcnt(4)
  buffer_load_dwordx4 v[192:195], v8, s[40:43], 0 offen nt
  v_add_u32 v8, 4096, v8
  v_and_b32_dpp v16, v50, v4 row_newbcast:2 row_mask:0xf bank_mask:0xf
  v_and_b32_dpp v17, v50, v5 row_newbcast:2 row_mask:0xf bank_mask:0xf
  v_and_b32_dpp v18, v50, v6 row_newbcast:2 row_mask:0xf bank_mask:0xf
  v_and_b32_dpp v19, v50, v7 row_newbcast:2 row_mask:0xf bank_mask:0xf
  v_mfma_f32_16x16x32_bf16 v[24:27], v[20:23], v[196:199], v[24:27]
  s_waitcnt vmcnt(4)
  buffer_load_dwordx4 v[196:199], v8, s[40:43], 0 offen nt
  v_add_u32 v8, 4096, v8
  v_and_b32_dpp v20, v50, v4 row_newbcast:3 row_mask:0xf bank_mask:0xf
  v_and_b32_dpp v21, v50, v5 row_newbcast:3 row_mask:0xf bank_mask:0xf
  v_and_b32_dpp v22, v50, v6 row_newbcast:3 row_mask:0xf bank_mask:0xf
  v_and_b32_dpp v23, v50, v7 row_newbcast:3 row_mask:0xf bank_mask:0xf
  v_mfma_f32_16x16x32_bf16 v[24:27], v[16:19], v[200:203], v[24:27]
  s_waitcnt vmcnt(4)
  buffer_load_dwordx4 v[200:203], v8, s[40:43], 0 offen nt
  v_add_u32 v8, 4096, v8
  v_and_b32_dpp v16, v50, v4 row_newbcast:4 row_mask:0xf bank_mask:0xf
  v_and_b32_dpp v17, v50, v5 row_newbcast:4 row_mask:0xf bank_mask:0xf
  v_and_b32_dpp v18, v50, v6 row_newbcast:4 row_mask:0xf bank_mask:0xf
  v_and_b32_dpp v19, v50, v7 row_newbcast:4 row_mask:0xf bank_mask:0xf
  v_mfma_f32_16x16x32_bf16 v[24:27], v[20:23], v[204:207], v[24:27]
  s_waitcnt vmcnt(4)
  buffer_load_dwordx4 v[204:207], v8, s[40:43], 0 offen nt
  v_add_u32 v8, 4096, v8
  v_and_b32_dpp v20, v50, v4 row_newbcast:5 row_mask:0xf bank_mask:0xf
  v_and_b32_dpp v21, v50, v5 row_newbcast:5 row_mask:0xf bank_mask:0xf
  v_and_b32_dpp v22, v50, v6 row_newbcast:5 row_mask:0xf bank_mask:0xf
  v_and_b32_dpp v23, v50, v7 row_newbcast:5 row_mask:0xf bank_mask:0xf
  v_mfma_f32_16x16x32_bf16 v[24:27], v[16:19], v[208:211], v[24:27]
  s_waitcnt vmcnt(4)
  buffer_load_dwordx4 v[208:211], v8, s[40:43], 0 offen nt
  v_add_u32 v8, 4096, v8
  v_and_b32_dpp v16, v50, v4 row_newbcast:6 row_mask:0xf bank_mask:0xf
  v_and_b32_dpp v17, v50, v5 row_newbcast:6 row_mask:0xf bank_mask:0xf
  v_and_b32_dpp v18, v50, v6 row_newbcast:6 row_mask:0xf bank_mask:0xf
  v_and_b32_dpp v19, v50, v7 row_newbcast:6 row_mask:0xf bank_mask:0xf
  v_mfma_f32_16x16x32_bf16 v[24:27], v[20:23], v[212:215], v[24:27]
  s_waitcnt vmcnt(4)
  buffer_load_dwordx4 v[212:215], v8, s[40:43], 0 offen nt
  v_add_u32 v8, 4096, v8
  v_and_b32_dpp v20, v50, v4 row_newbcast:7 row_mask:0xf bank_mask:0xf
  v_and_b32_dpp v21, v50, v5 row_newbcast:7 row_mask:0xf bank_mask:0xf
  v_and_b32_dpp v22, v50, v6 row_newbcast:7 row_mask:0xf bank_mask:0xf
  v_and_b32_dpp v23, v50, v7 row_newbcast:7 row_mask:0xf bank_mask:0xf
  v_mfma_f32_16x16x32_bf16 v[24:27], v[16:19], v[216:219], v[24:27]
  s_waitcnt vmcnt(4)
  buffer_load_dwordx4 v[216:219], v8, s[40:43], 0 offen nt
  v_add_u32 v8, 4096, v8
  v_and_b32_dpp v16, v50, v4 row_newbcast:8 row_mask:0xf bank_mask:0xf
  v_and_b32_dpp v17, v50, v5 row_newbcast:8 row_mask:0xf bank_mask:0xf
  v_and_b32_dpp v18, v50, v6 row_newbcast:8 row_mask:0xf bank_mask:0xf
  v_and_b32_dpp v19, v50, v7 row_newbcast:8 row_mask:0xf bank_mask:0xf
  v_mfma_f32_16x16x32_bf16 v[24:27], v[20:23], v[220:223], v[24:27]
  s_waitcnt vmcnt(4)
  buffer_load_dwordx4 v[220:223], v8, s[40:43], 0 offen nt
  v_add_u32 v8, 4096, v8
  v_and_b32_dpp v20, v50, v4 row_newbcast:9 row_mask:0xf bank_mask:0xf
  v_and_b32_dpp v21, v50, v5 row_newbcast:9 row_mask:0xf bank_mask:0xf
  v_and_b32_dpp v22, v50, v6 row_newbcast:9 row_mask:0xf bank_mask:0xf
  v_and_b32_dpp v23, v50, v7 row_newbcast:9 row_mask:0xf bank_mask:0xf
  v_mfma_f32_16x16x32_bf16 v[24:27], v[16:19], v[224:227], v[24:27]
  s_waitcnt vmcnt(4)
  buffer_load_dwordx4 v[224:227], v8, s[40:43], 0 offen nt
  v_add_u32 v8, 4096, v8
  v_and_b32_dpp v16, v50, v4 row_newbcast:10 row_mask:0xf bank_mask:0xf
  v_and_b32_dpp v17, v50, v5 row_newbcast:10 row_mask:0xf bank_mask:0xf
  v_and_b32_dpp v18, v50, v6 row_newbcast:10 row_mask:0xf bank_mask:0xf
  v_and_b32_dpp v19, v50, v7 row_newbcast:10 row_mask:0xf bank_mask:0xf
  v_mfma_f32_16x16x32_bf16 v[24:27], v[20:23], v[228:231], v[24:27]
  s_waitcnt vmcnt(4)
  buffer_load_dwordx4 v[228:231], v8, s[40:43], 0 offen nt
  v_add_u32 v8, 4096, v8
  v_and_b32_dpp v20, v50, v4 row_newbcast:11 row_mask:0xf bank_mask:0xf
  v_and_b32_dpp v21, v50, v5 row_newbcast:11 row_mask:0xf bank_mask:0xf
  v_and_b32_dpp v22, v50, v6 row_newbcast:11 row_mask:0xf bank_mask:0xf
  v_and_b32_dpp v23, v50, v7 row_newbcast:11 row_mask:0xf bank_mask:0xf
  v_mfma_f32_16x16x32_bf16 v[24:27], v[16:19], v[232:235], v[24:27]
  s_waitcnt vmcnt(4)
  buffer_load_dwordx4 v[232:235], v8, s[40:43], 0 offen nt
  v_add_u32 v8, 4096, v8
  v_and_b32_dpp v16, v50, v4 row_newbcast:12 row_mask:0xf bank_mask:0xf
  v_and_b32_dpp v17, v50, v5 row_newbcast:12 row_mask:0xf bank_mask:0xf
  v_and_b32_dpp v18, v50, v6 row_newbcast:12 row_mask:0xf bank_mask:0xf
  v_and_b32_dpp v19, v50, v7 row_newbcast:12 row_mask:0xf bank_mask:0xf
  v_mfma_f32_16x16x32_bf16 v[24:27], v[20:23], v[236:239], v[24:27]
  s_waitcnt vmcnt(4)
  buffer_load_dwordx4 v[236:239], v8, s[40:43], 0 offen nt
  v_add_u32 v8, 4096, v8
  v_and_b32_dpp v20, v50, v4 row_newbcast:13 row_mask:0xf bank_mask:0xf
  v_and_b32_dpp v21, v50, v5 row_newbcast:13 row_mask:0xf bank_mask:0xf
  v_and_b32_dpp v22, v50, v6 row_newbcast:13 row_mask:0xf bank_mask:0xf
  v_and_b32_dpp v23, v50, v7 row_newbcast:13 row_mask:0xf bank_mask:0xf
  v_mfma_f32_16x16x32_bf16 v[24:27], v[16:19], v[240:243], v[24:27]
  s_waitcnt vmcnt(4)
  buffer_load_dwordx4 v[240:243], v8, s[40:43], 0 offen nt
  v_add_u32 v8, 4096, v8
  v_and_b32_dpp v16, v50, v4 row_newbcast:14 row_mask:0xf bank_mask:0xf
  v_and_b32_dpp v17, v50, v5 row_newbcast:14 row_mask:0xf bank_mask:0xf
  v_and_b32_dpp v18, v50, v6 row_newbcast:14 row_mask:0xf bank_mask:0xf
  v_and_b32_dpp v19, v50, v7 row_newbcast:14 row_mask:0xf bank_mask:0xf
  v_mfma_f32_16x16x32_bf16 v[24:27], v[20:23], v[244:247], v[24:27]
  s_waitcnt vmcnt(4)
  buffer_load_dwordx4 v[244:247], v8, s[40:43], 0 offen nt
  v_add_u32 v8, 4096, v8
  v_and_b32_dpp v20, v50, v4 row_newbcast:15 row_mask:0xf bank_mask:0xf
  v_and_b32_dpp v21, v50, v5 row_newbcast:15 row_mask:0xf bank_mask:0xf
  v_and_b32_dpp v22, v50, v6 row_newbcast:15 row_mask:0xf bank_mask:0xf
  v_and_b32_dpp v23, v50, v7 row_newbcast:15 row_mask:0xf bank_mask:0xf
  v_mfma_f32_16x16x32_bf16 v[24:27], v[16:19], v[248:251], v[24:27]
  s_waitcnt vmcnt(4)
  buffer_load_dwordx4 v[248:251], v8, s[40:43], 0 offen nt
  v_add_u32 v8, 4096, v8
  s_nop 0
  v_mfma_f32_16x16x32_bf16 v[24:27], v[20:23], v[252:255], v[24:27]
  s_waitcnt vmcnt(4)
  buffer_load_dwordx4 v[252:255], v8, s[40:43], 0 offen nt
  v_add_u32 v8, 4096, v8
  s_waitcnt lgkmcnt(0)
  v_subrev_f32 v10, s54, v51
  v_mul_f32 v10, s53, v10
  v_exp_f32 v10, v10
  ds_read_b32 v51, v52 offset:768
  v_add_f32 v49, v49, v10
  v_cvt_pk_bf16_f32 v50, v10, v10
  s_nop 1
  v_and_b32_dpp v16, v50, v4 row_newbcast:0 row_mask:0xf bank_mask:0xf
  v_and_b32_dpp v17, v50, v5 row_newbcast:0 row_mask:0xf bank_mask:0xf
  v_and_b32_dpp v18, v50, v6 row_newbcast:0 row_mask:0xf bank_mask:0xf
  v_and_b32_dpp v19, v50, v7 row_newbcast:0 row_mask:0xf bank_mask:0xf
  v_and_b32_dpp v20, v50, v4 row_newbcast:1 row_mask:0xf bank_mask:0xf
  v_and_b32_dpp v21, v50, v5 row_newbcast:1 row_mask:0xf bank_mask:0xf
  v_and_b32_dpp v22, v50, v6 row_newbcast:1 row_mask:0xf bank_mask:0xf
  v_and_b32_dpp v23, v50, v7 row_newbcast:1 row_mask:0xf bank_mask:0xf
  v_mfma_f32_16x16x32_bf16 v[24:27], v[16:19], v[64:67], v[24:27]
  s_waitcnt vmcnt(4)
  buffer_load_dwordx4 v[64:67], v8, s[40:43], 0 offen nt
  v_add_u32 v8, 4096, v8
  v_and_b32_dpp v16, v50, v4 row_newbcast:2 row_mask:0xf bank_mask:0xf
  v_and_b32_dpp v17, v50, v5 row_newbcast:2 row_mask:0xf bank_mask:0xf
  v_and_b32_dpp v18, v50, v6 row_newbcast:2 row_mask:0xf bank_mask:0xf
  v_and_b32_dpp v19, v50, v7 row_newbcast:2 row_mask:0xf bank_mask:0xf
  v_mfma_f32_16x16x32_bf16 v[24:27], v[20:23], v[68:71], v[24:27]
  s_waitcnt vmcnt(4)
  buffer_load_dwordx4 v[68:71], v8, s[40:43], 0 offen nt
  v_add_u32 v8, 4096, v8
  v_and_b32_dpp v20, v50, v4 row_newbcast:3 row_mask:0xf bank_mask:0xf
  v_and_b32_dpp v21, v50, v5 row_newbcast:3 row_mask:0xf bank_mask:0xf
  v_and_b32_dpp v22, v50, v6 row_newbcast:3 row_mask:0xf bank_mask:0xf
  v_and_b32_dpp v23, v50, v7 row_newbcast:3 row_mask:0xf bank_mask:0xf
  v_mfma_f32_16x16x32_bf16 v[24:27], v[16:19], v[72:75], v[24:27]
  s_waitcnt vmcnt(4)
  buffer_load_dwordx4 v[72:75], v8, s[40:43], 0 offen nt
  v_add_u32 v8, 4096, v8
  v_and_b32_dpp v16, v50, v4 row_newbcast:4 row_mask:0xf bank_mask:0xf
  v_and_b32_dpp v17, v50, v5 row_newbcast:4 row_mask:0xf bank_mask:0xf
  v_and_b32_dpp v18, v50, v6 row_newbcast:4 row_mask:0xf bank_mask:0xf
  v_and_b32_dpp v19, v50, v7 row_newbcast:4 row_mask:0xf bank_mask:0xf
  v_mfma_f32_16x16x32_bf16 v[24:27], v[20:23], v[76:79], v[24:27]
  s_waitcnt vmcnt(4)
  buffer_load_dwordx4 v[76:79], v8, s[40:43], 0 offen nt
  v_add_u32 v8, 4096, v8
  v_and_b32_dpp v20, v50, v4 row_newbcast:5 row_mask:0xf bank_mask:0xf
  v_and_b32_dpp v21, v50, v5 row_newbcast:5 row_mask:0xf bank_mask:0xf
  v_and_b32_dpp v22, v50, v6 row_newbcast:5 row_mask:0xf bank_mask:0xf
  v_and_b32_dpp v23, v50, v7 row_newbcast:5 row_mask:0xf bank_mask:0xf
  v_mfma_f32_16x16x32_bf16 v[24:27], v[16:19], v[80:83], v[24:27]
  s_waitcnt vmcnt(4)
  buffer_load_dwordx4 v[80:83], v8, s[40:43], 0 offen nt
  v_add_u32 v8, 4096, v8
  v_and_b32_dpp v16, v50, v4 row_newbcast:6 row_mask:0xf bank_mask:0xf
  v_and_b32_dpp v17, v50, v5 row_newbcast:6 row_mask:0xf bank_mask:0xf
  v_and_b32_dpp v18, v50, v6 row_newbcast:6 row_mask:0xf bank_mask:0xf
  v_and_b32_dpp v19, v50, v7 row_newbcast:6 row_mask:0xf bank_mask:0xf
  v_mfma_f32_16x16x32_bf16 v[24:27], v[20:23], v[84:87], v[24:27]
  s_waitcnt vmcnt(4)
  buffer_load_dwordx4 v[84:87], v8, s[40:43], 0 offen nt
  v_add_u32 v8, 4096, v8
  v_and_b32_dpp v20, v50, v4 row_newbcast:7 row_mask:0xf bank_mask:0xf
  v_and_b32_dpp v21, v50, v5 row_newbcast:7 row_mask:0xf bank_mask:0xf
  v_and_b32_dpp v22, v50, v6 row_newbcast:7 row_mask:0xf bank_mask:0xf
  v_and_b32_dpp v23, v50, v7 row_newbcast:7 row_mask:0xf bank_mask:0xf
  v_mfma_f32_16x16x32_bf16 v[24:27], v[16:19], v[88:91], v[24:27]
  s_waitcnt vmcnt(4)
  buffer_load_dwordx4 v[88:91], v8, s[40:43], 0 offen nt
  v_add_u32 v8, 4096, v8
  v_and_b32_dpp v16, v50, v4 row_newbcast:8 row_mask:0xf bank_mask:0xf
  v_and_b32_dpp v17, v50, v5 row_newbcast:8 row_mask:0xf bank_mask:0xf
  v_and_b32_dpp v18, v50, v6 row_newbcast:8 row_mask:0xf bank_mask:0xf
  v_and_b32_dpp v19, v50, v7 row_newbcast:8 row_mask:0xf bank_mask:0xf
  v_mfma_f32_16x16x32_bf16 v[24:27], v[20:23], v[92:95], v[24:27]
  s_waitcnt vmcnt(4)
  buffer_load_dwordx4 v[92:95], v8, s[40:43], 0 offen nt
  v_add_u32 v8, 4096, v8
  v_and_b32_dpp v20, v50, v4 row_newbcast:9 row_mask:0xf bank_mask:0xf
  v_and_b32_dpp v21, v50, v5 row_newbcast:9 row_mask:0xf bank_mask:0xf
  v_and_b32_dpp v22, v50, v6 row_newbcast:9 row_mask:0xf bank_mask:0xf
  v_and_b32_dpp v23, v50, v7 row_newbcast:9 row_mask:0xf bank_mask:0xf
  v_mfma_f32_16x16x32_bf16 v[24:27], v[16:19], v[96:99], v[24:27]
  s_waitcnt vmcnt(4)
  buffer_load_dwordx4 v[96:99], v8, s[40:43], 0 offen nt
  v_add_u32 v8, 4096, v8
  v_and_b32_dpp v16, v50, v4 row_newbcast:10 row_mask:0xf bank_mask:0xf
  v_and_b32_dpp v17, v50, v5 row_newbcast:10 row_mask:0xf bank_mask:0xf
  v_and_b32_dpp v18, v50, v6 row_newbcast:10 row_mask:0xf bank_mask:0xf
  v_and_b32_dpp v19, v50, v7 row_newbcast:10 row_mask:0xf bank_mask:0xf
  v_mfma_f32_16x16x32_bf16 v[24:27], v[20:23], v[100:103], v[24:27]
  s_waitcnt vmcnt(4)
  buffer_load_dwordx4 v[100:103], v8, s[40:43], 0 offen nt
  v_add_u32 v8, 4096, v8
  v_and_b32_dpp v20, v50, v4 row_newbcast:11 row_mask:0xf bank_mask:0xf
  v_and_b32_dpp v21, v50, v5 row_newbcast:11 row_mask:0xf bank_mask:0xf
  v_and_b32_dpp v22, v50, v6 row_newbcast:11 row_mask:0xf bank_mask:0xf
  v_and_b32_dpp v23, v50, v7 row_newbcast:11 row_mask:0xf bank_mask:0xf
  v_mfma_f32_16x16x32_bf16 v[24:27], v[16:19], v[104:107], v[24:27]
  s_waitcnt vmcnt(4)
  buffer_load_dwordx4 v[104:107], v8, s[40:43], 0 offen nt
  v_add_u32 v8, 4096, v8
  v_and_b32_dpp v16, v50, v4 row_newbcast:12 row_mask:0xf bank_mask:0xf
  v_and_b32_dpp v17, v50, v5 row_newbcast:12 row_mask:0xf bank_mask:0xf
  v_and_b32_dpp v18, v50, v6 row_newbcast:12 row_mask:0xf bank_mask:0xf
  v_and_b32_dpp v19, v50, v7 row_newbcast:12 row_mask:0xf bank_mask:0xf
  v_mfma_f32_16x16x32_bf16 v[24:27], v[20:23], v[108:111], v[24:27]
  s_waitcnt vmcnt(4)
  buffer_load_dwordx4 v[108:111], v8, s[40:43], 0 offen nt
  v_add_u32 v8, 4096, v8
  v_and_b32_dpp v20, v50, v4 row_newbcast:13 row_mask:0xf bank_mask:0xf
  v_and_b32_dpp v21, v50, v5 row_newbcast:13 row_mask:0xf bank_mask:0xf
  v_and_b32_dpp v22, v50, v6 row_newbcast:13 row_mask:0xf bank_mask:0xf
  v_and_b32_dpp v23, v50, v7 row_newbcast:13 row_mask:0xf bank_mask:0xf
  v_mfma_f32_16x16x32_bf16 v[24:27], v[16:19], v[112:115], v[24:27]
  s_waitcnt vmcnt(4)
  buffer_load_dwordx4 v[112:115], v8, s[40:43], 0 offen nt
  v_add_u32 v8, 4096, v8
  v_and_b32_dpp v16, v50, v4 row_newbcast:14 row_mask:0xf bank_mask:0xf
  v_and_b32_dpp v17, v50, v5 row_newbcast:14 row_mask:0xf bank_mask:0xf
  v_and_b32_dpp v18, v50, v6 row_newbcast:14 row_mask:0xf bank_mask:0xf
  v_and_b32_dpp v19, v50, v7 row_newbcast:14 row_mask:0xf bank_mask:0xf
  v_mfma_f32_16x16x32_bf16 v[24:27], v[20:23], v[116:119], v[24:27]
  s_waitcnt vmcnt(4)
  buffer_load_dwordx4 v[116:119], v8, s[40:43], 0 offen nt
  v_add_u32 v8, 4096, v8
  v_and_b32_dpp v20, v50, v4 row_newbcast:15 row_mask:0xf bank_mask:0xf
  v_and_b32_dpp v21, v50, v5 row_newbcast:15 row_mask:0xf bank_mask:0xf
  v_and_b32_dpp v22, v50, v6 row_newbcast:15 row_mask:0xf bank_mask:0xf
  v_and_b32_dpp v23, v50, v7 row_newbcast:15 row_mask:0xf bank_mask:0xf
  v_mfma_f32_16x16x32_bf16 v[24:27], v[16:19], v[120:123], v[24:27]
  s_waitcnt vmcnt(4)
  buffer_load_dwordx4 v[120:123], v8, s[40:43], 0 offen nt
  v_add_u32 v8, 4096, v8
  s_nop 0
  v_mfma_f32_16x16x32_bf16 v[24:27], v[20:23], v[124:127], v[24:27]
  s_waitcnt vmcnt(4)
  buffer_load_dwordx4 v[124:127], v8, s[40:43], 0 offen nt
  v_add_u32 v8, 4096, v8
  v_add_u32 v52, 768, v52
  s_add_u32 s49, s49, 1
  s_cmp_lt_u32 s49, 3
  s_cbranch_scc1 L_vloop
  s_lshl_b32 s50, s31, 2
  s_add_u32 s50, s50, s30
  s_lshl_b32 s50, s50, 3
  v_mov_b32 v54, s50
  global_load_dword v53, v54, s[26:27] sc1
  s_bfe_u32 s50, s3, 0x20001
  s_lshl_b32 s50, s50, 2
  s_add_u32 s50, s50, s30
  s_lshl_b32 s50, s50, 6
  v_and_b32 v11, 7, v1
  v_lshlrev_b32 v11, 3, v11
  v_add_u32 v11, s50, v11
  s_lshl_b32 s50, s31, 10
  v_add_u32 v12, s50, v11
  global_load_dwordx2 v[56:57], v12, s[4:5]
  global_load_dwordx2 v[58:59], v11, s[22:23]
  s_waitcnt lgkmcnt(0)
  v_subrev_f32 v10, s54, v51
  v_mul_f32 v10, s53, v10
  v_exp_f32 v10, v10
  ds_read_b32 v51, v52 offset:256
  v_add_f32 v49, v49, v10
  v_cvt_pk_bf16_f32 v50, v10, v10
  s_nop 1
  v_and_b32_dpp v16, v50, v4 row_newbcast:0 row_mask:0xf bank_mask:0xf
  v_and_b32_dpp v17, v50, v5 row_newbcast:0 row_mask:0xf bank_mask:0xf
  v_and_b32_dpp v18, v50, v6 row_newbcast:0 row_mask:0xf bank_mask:0xf
  v_and_b32_dpp v19, v50, v7 row_newbcast:0 row_mask:0xf bank_mask:0xf
  v_and_b32_dpp v20, v50, v4 row_newbcast:1 row_mask:0xf bank_mask:0xf
  v_and_b32_dpp v21, v50, v5 row_newbcast:1 row_mask:0xf bank_mask:0xf
  v_and_b32_dpp v22, v50, v6 row_newbcast:1 row_mask:0xf bank_mask:0xf
  v_and_b32_dpp v23, v50, v7 row_newbcast:1 row_mask:0xf bank_mask:0xf
  v_mfma_f32_16x16x32_bf16 v[24:27], v[16:19], v[128:131], v[24:27]
  s_waitcnt vmcnt(4)
  buffer_load_dwordx4 v[128:131], v8, s[40:43], 0 offen nt
  v_add_u32 v8, 4096, v8
  v_and_b32_dpp v16, v50, v4 row_newbcast:2 row_mask:0xf bank_mask:0xf
  v_and_b32_dpp v17, v50, v5 row_newbcast:2 row_mask:0xf bank_mask:0xf
  v_and_b32_dpp v18, v50, v6 row_newbcast:2 row_mask:0xf bank_mask:0xf
  v_and_b32_dpp v19, v50, v7 row_newbcast:2 row_mask:0xf bank_mask:0xf
  v_mfma_f32_16x16x32_bf16 v[24:27], v[20:23], v[132:135], v[24:27]
  s_waitcnt vmcnt(4)
  buffer_load_dwordx4 v[132:135], v8, s[40:43], 0 offen nt
  v_add_u32 v8, 4096, v8
  v_and_b32_dpp v20, v50, v4 row_newbcast:3 row_mask:0xf bank_mask:0xf
  v_and_b32_dpp v21, v50, v5 row_newbcast:3 row_mask:0xf bank_mask:0xf
  v_and_b32_dpp v22, v50, v6 row_newbcast:3 row_mask:0xf bank_mask:0xf
  v_and_b32_dpp v23, v50, v7 row_newbcast:3 row_mask:0xf bank_mask:0xf
  v_mfma_f32_16x16x32_bf16 v[24:27], v[16:19], v[136:139], v[24:27]
  s_waitcnt vmcnt(4)
  buffer_load_dwordx4 v[136:139], v8, s[40:43], 0 offen nt
  v_add_u32 v8, 4096, v8
  v_and_b32_dpp v16, v50, v4 row_newbcast:4 row_mask:0xf bank_mask:0xf
  v_and_b32_dpp v17, v50, v5 row_newbcast:4 row_mask:0xf bank_mask:0xf
  v_and_b32_dpp v18, v50, v6 row_newbcast:4 row_mask:0xf bank_mask:0xf
  v_and_b32_dpp v19, v50, v7 row_newbcast:4 row_mask:0xf bank_mask:0xf
  v_mfma_f32_16x16x32_bf16 v[24:27], v[20:23], v[140:143], v[24:27]
  s_waitcnt vmcnt(4)
  buffer_load_dwordx4 v[140:143], v8, s[40:43], 0 offen nt
  v_add_u32 v8, 4096, v8
  v_and_b32_dpp v20, v50, v4 row_newbcast:5 row_mask:0xf bank_mask:0xf
  v_and_b32_dpp v21, v50, v5 row_newbcast:5 row_mask:0xf bank_mask:0xf
  v_and_b32_dpp v22, v50, v6 row_newbcast:5 row_mask:0xf bank_mask:0xf
  v_and_b32_dpp v23, v50, v7 row_newbcast:5 row_mask:0xf bank_mask:0xf
  v_mfma_f32_16x16x32_bf16 v[24:27], v[16:19], v[144:147], v[24:27]
  s_waitcnt vmcnt(4)
  buffer_load_dwordx4 v[144:147], v8, s[40:43], 0 offen nt
  v_add_u32 v8, 4096, v8
  v_and_b32_dpp v16, v50, v4 row_newbcast:6 row_mask:0xf bank_mask:0xf
  v_and_b32_dpp v17, v50, v5 row_newbcast:6 row_mask:0xf bank_mask:0xf
  v_and_b32_dpp v18, v50, v6 row_newbcast:6 row_mask:0xf bank_mask:0xf
  v_and_b32_dpp v19, v50, v7 row_newbcast:6 row_mask:0xf bank_mask:0xf
  v_mfma_f32_16x16x32_bf16 v[24:27], v[20:23], v[148:151], v[24:27]
  s_waitcnt vmcnt(4)
  buffer_load_dwordx4 v[148:151], v8, s[40:43], 0 offen nt
  v_add_u32 v8, 4096, v8
  v_and_b32_dpp v20, v50, v4 row_newbcast:7 row_mask:0xf bank_mask:0xf
  v_and_b32_dpp v21, v50, v5 row_newbcast:7 row_mask:0xf bank_mask:0xf
  v_and_b32_dpp v22, v50, v6 row_newbcast:7 row_mask:0xf bank_mask:0xf
  v_and_b32_dpp v23, v50, v7 row_newbcast:7 row_mask:0xf bank_mask:0xf
  v_mfma_f32_16x16x32_bf16 v[24:27], v[16:19], v[152:155], v[24:27]
  s_waitcnt vmcnt(4)
  buffer_load_dwordx4 v[152:155], v8, s[40:43], 0 offen nt
  v_add_u32 v8, 4096, v8
  v_and_b32_dpp v16, v50, v4 row_newbcast:8 row_mask:0xf bank_mask:0xf
  v_and_b32_dpp v17, v50, v5 row_newbcast:8 row_mask:0xf bank_mask:0xf
  v_and_b32_dpp v18, v50, v6 row_newbcast:8 row_mask:0xf bank_mask:0xf
  v_and_b32_dpp v19, v50, v7 row_newbcast:8 row_mask:0xf bank_mask:0xf
  v_mfma_f32_16x16x32_bf16 v[24:27], v[20:23], v[156:159], v[24:27]
  s_waitcnt vmcnt(4)
  buffer_load_dwordx4 v[156:159], v8, s[40:43], 0 offen nt
  v_add_u32 v8, 4096, v8
  v_and_b32_dpp v20, v50, v4 row_newbcast:9 row_mask:0xf bank_mask:0xf
  v_and_b32_dpp v21, v50, v5 row_newbcast:9 row_mask:0xf bank_mask:0xf
  v_and_b32_dpp v22, v50, v6 row_newbcast:9 row_mask:0xf bank_mask:0xf
  v_and_b32_dpp v23, v50, v7 row_newbcast:9 row_mask:0xf bank_mask:0xf
  v_mfma_f32_16x16x32_bf16 v[24:27], v[16:19], v[160:163], v[24:27]
  s_waitcnt vmcnt(4)
  buffer_load_dwordx4 v[160:163], v8, s[40:43], 0 offen nt
  v_add_u32 v8, 4096, v8
  v_and_b32_dpp v16, v50, v4 row_newbcast:10 row_mask:0xf bank_mask:0xf
  v_and_b32_dpp v17, v50, v5 row_newbcast:10 row_mask:0xf bank_mask:0xf
  v_and_b32_dpp v18, v50, v6 row_newbcast:10 row_mask:0xf bank_mask:0xf
  v_and_b32_dpp v19, v50, v7 row_newbcast:10 row_mask:0xf bank_mask:0xf
  v_mfma_f32_16x16x32_bf16 v[24:27], v[20:23], v[164:167], v[24:27]
  s_waitcnt vmcnt(4)
  buffer_load_dwordx4 v[164:167], v8, s[40:43], 0 offen nt
  v_add_u32 v8, 4096, v8
  v_and_b32_dpp v20, v50, v4 row_newbcast:11 row_mask:0xf bank_mask:0xf
  v_and_b32_dpp v21, v50, v5 row_newbcast:11 row_mask:0xf bank_mask:0xf
  v_and_b32_dpp v22, v50, v6 row_newbcast:11 row_mask:0xf bank_mask:0xf
  v_and_b32_dpp v23, v50, v7 row_newbcast:11 row_mask:0xf bank_mask:0xf
  v_mfma_f32_16x16x32_bf16 v[24:27], v[16:19], v[168:171], v[24:27]
  s_waitcnt vmcnt(4)
  buffer_load_dwordx4 v[168:171], v8, s[40:43], 0 offen nt
  v_add_u32 v8, 4096, v8
  v_and_b32_dpp v16, v50, v4 row_newbcast:12 row_mask:0xf bank_mask:0xf
  v_and_b32_dpp v17, v50, v5 row_newbcast:12 row_mask:0xf bank_mask:0xf
  v_and_b32_dpp v18, v50, v6 row_newbcast:12 row_mask:0xf bank_mask:0xf
  v_and_b32_dpp v19, v50, v7 row_newbcast:12 row_mask:0xf bank_mask:0xf
  v_mfma_f32_16x16x32_bf16 v[24:27], v[20:23], v[172:175], v[24:27]
  s_waitcnt vmcnt(4)
  buffer_load_dwordx4 v[172:175], v8, s[40:43], 0 offen nt
  v_add_u32 v8, 4096, v8
  v_and_b32_dpp v20, v50, v4 row_newbcast:13 row_mask:0xf bank_mask:0xf
  v_and_b32_dpp v21, v50, v5 row_newbcast:13 row_mask:0xf bank_mask:0xf
  v_and_b32_dpp v22, v50, v6 row_newbcast:13 row_mask:0xf bank_mask:0xf
  v_and_b32_dpp v23, v50, v7 row_newbcast:13 row_mask:0xf bank_mask:0xf
  v_mfma_f32_16x16x32_bf16 v[24:27], v[16:19], v[176:179], v[24:27]
  s_waitcnt vmcnt(4)
  buffer_load_dwordx4 v[176:179], v8, s[40:43], 0 offen nt
  v_add_u32 v8, 4096, v8
  v_and_b32_dpp v16, v50, v4 row_newbcast:14 row_mask:0xf bank_mask:0xf
  v_and_b32_dpp v17, v50, v5 row_newbcast:14 row_mask:0xf bank_mask:0xf
  v_and_b32_dpp v18, v50, v6 row_newbcast:14 row_mask:0xf bank_mask:0xf
  v_and_b32_dpp v19, v50, v7 row_newbcast:14 row_mask:0xf bank_mask:0xf
  v_mfma_f32_16x16x32_bf16 v[24:27], v[20:23], v[180:183], v[24:27]
  s_waitcnt vmcnt(4)
  buffer_load_dwordx4 v[180:183], v8, s[40:43], 0 offen nt
  v_add_u32 v8, 4096, v8
  v_and_b32_dpp v20, v50, v4 row_newbcast:15 row_mask:0xf bank_mask:0xf
  v_and_b32_dpp v21, v50, v5 row_newbcast:15 row_mask:0xf bank_mask:0xf
  v_and_b32_dpp v22, v50, v6 row_newbcast:15 row_mask:0xf bank_mask:0xf
  v_and_b32_dpp v23, v50, v7 row_newbcast:15 row_mask:0xf bank_mask:0xf
  v_mfma_f32_16x16x32_bf16 v[24:27], v[16:19], v[184:187], v[24:27]
  s_waitcnt vmcnt(4)
  buffer_load_dwordx4 v[184:187], v8, s[40:43], 0 offen nt
  v_add_u32 v8, 4096, v8
  s_nop 0
  v_mfma_f32_16x16x32_bf16 v[24:27], v[20:23], v[188:191], v[24:27]
  s_waitcnt vmcnt(4)
  buffer_load_dwordx4 v[188:191], v8, s[40:43], 0 offen nt
  v_add_u32 v8, 4096, v8
  s_waitcnt lgkmcnt(0)
  v_subrev_f32 v10, s54, v51
  v_mul_f32 v10, s53, v10
  v_exp_f32 v10, v10
  ds_read_b32 v51, v52 offset:512
  v_add_f32 v49, v49, v10
  v_cvt_pk_bf16_f32 v50, v10, v10
  s_nop 1
  v_and_b32_dpp v16, v50, v4 row_newbcast:0 row_mask:0xf bank_mask:0xf
  v_and_b32_dpp v17, v50, v5 row_newbcast:0 row_mask:0xf bank_mask:0xf
  v_and_b32_dpp v18, v50, v6 row_newbcast:0 row_mask:0xf bank_mask:0xf
  v_and_b32_dpp v19, v50, v7 row_newbcast:0 row_mask:0xf bank_mask:0xf
  v_and_b32_dpp v20, v50, v4 row_newbcast:1 row_mask:0xf bank_mask:0xf
  v_and_b32_dpp v21, v50, v5 row_newbcast:1 row_mask:0xf bank_mask:0xf
  v_and_b32_dpp v22, v50, v6 row_newbcast:1 row_mask:0xf bank_mask:0xf
  v_and_b32_dpp v23, v50, v7 row_newbcast:1 row_mask:0xf bank_mask:0xf
  v_mfma_f32_16x16x32_bf16 v[24:27], v[16:19], v[192:195], v[24:27]
  s_waitcnt vmcnt(15)
  buffer_load_dwordx4 v[192:195], v8, s[40:43], 0 offen nt
  v_add_u32 v8, 4096, v8
  v_and_b32_dpp v16, v50, v4 row_newbcast:2 row_mask:0xf bank_mask:0xf
  v_and_b32_dpp v17, v50, v5 row_newbcast:2 row_mask:0xf bank_mask:0xf
  v_and_b32_dpp v18, v50, v6 row_newbcast:2 row_mask:0xf bank_mask:0xf
  v_and_b32_dpp v19, v50, v7 row_newbcast:2 row_mask:0xf bank_mask:0xf
  v_mfma_f32_16x16x32_bf16 v[24:27], v[20:23], v[196:199], v[24:27]
  s_waitcnt vmcnt(15)
  buffer_load_dwordx4 v[196:199], v8, s[40:43], 0 offen nt
  v_add_u32 v8, 4096, v8
  v_and_b32_dpp v20, v50, v4 row_newbcast:3 row_mask:0xf bank_mask:0xf
  v_and_b32_dpp v21, v50, v5 row_newbcast:3 row_mask:0xf bank_mask:0xf
  v_and_b32_dpp v22, v50, v6 row_newbcast:3 row_mask:0xf bank_mask:0xf
  v_and_b32_dpp v23, v50, v7 row_newbcast:3 row_mask:0xf bank_mask:0xf
  v_mfma_f32_16x16x32_bf16 v[24:27], v[16:19], v[200:203], v[24:27]
  s_waitcnt vmcnt(15)
  buffer_load_dwordx4 v[200:203], v8, s[40:43], 0 offen nt
  v_add_u32 v8, 4096, v8
  v_and_b32_dpp v16, v50, v4 row_newbcast:4 row_mask:0xf bank_mask:0xf
  v_and_b32_dpp v17, v50, v5 row_newbcast:4 row_mask:0xf bank_mask:0xf
  v_and_b32_dpp v18, v50, v6 row_newbcast:4 row_mask:0xf bank_mask:0xf
  v_and_b32_dpp v19, v50, v7 row_newbcast:4 row_mask:0xf bank_mask:0xf
  v_mfma_f32_16x16x32_bf16 v[24:27], v[20:23], v[204:207], v[24:27]
  s_waitcnt vmcnt(15)
  buffer_load_dwordx4 v[204:207], v8, s[40:43], 0 offen nt
  v_add_u32 v8, 4096, v8
  v_and_b32_dpp v20, v50, v4 row_newbcast:5 row_mask:0xf bank_mask:0xf
  v_and_b32_dpp v21, v50, v5 row_newbcast:5 row_mask:0xf bank_mask:0xf
  v_and_b32_dpp v22, v50, v6 row_newbcast:5 row_mask:0xf bank_mask:0xf
  v_and_b32_dpp v23, v50, v7 row_newbcast:5 row_mask:0xf bank_mask:0xf
  v_mfma_f32_16x16x32_bf16 v[24:27], v[16:19], v[208:211], v[24:27]
  s_waitcnt vmcnt(15)
  buffer_load_dwordx4 v[208:211], v8, s[40:43], 0 offen nt
  v_add_u32 v8, 4096, v8
  v_and_b32_dpp v16, v50, v4 row_newbcast:6 row_mask:0xf bank_mask:0xf
  v_and_b32_dpp v17, v50, v5 row_newbcast:6 row_mask:0xf bank_mask:0xf
  v_and_b32_dpp v18, v50, v6 row_newbcast:6 row_mask:0xf bank_mask:0xf
  v_and_b32_dpp v19, v50, v7 row_newbcast:6 row_mask:0xf bank_mask:0xf
  v_mfma_f32_16x16x32_bf16 v[24:27], v[20:23], v[212:215], v[24:27]
  s_waitcnt vmcnt(15)
  buffer_load_dwordx4 v[212:215], v8, s[40:43], 0 offen nt
  v_add_u32 v8, 4096, v8
  v_and_b32_dpp v20, v50, v4 row_newbcast:7 row_mask:0xf bank_mask:0xf
  v_and_b32_dpp v21, v50, v5 row_newbcast:7 row_mask:0xf bank_mask:0xf
  v_and_b32_dpp v22, v50, v6 row_newbcast:7 row_mask:0xf bank_mask:0xf
  v_and_b32_dpp v23, v50, v7 row_newbcast:7 row_mask:0xf bank_mask:0xf
  v_mfma_f32_16x16x32_bf16 v[24:27], v[16:19], v[216:219], v[24:27]
  s_waitcnt vmcnt(15)
  buffer_load_dwordx4 v[216:219], v8, s[40:43], 0 offen nt
  v_add_u32 v8, 4096, v8
  v_and_b32_dpp v16, v50, v4 row_newbcast:8 row_mask:0xf bank_mask:0xf
  v_and_b32_dpp v17, v50, v5 row_newbcast:8 row_mask:0xf bank_mask:0xf
  v_and_b32_dpp v18, v50, v6 row_newbcast:8 row_mask:0xf bank_mask:0xf
  v_and_b32_dpp v19, v50, v7 row_newbcast:8 row_mask:0xf bank_mask:0xf
  v_mfma_f32_16x16x32_bf16 v[24:27], v[20:23], v[220:223], v[24:27]
  s_waitcnt vmcnt(15)
  buffer_load_dwordx4 v[220:223], v8, s[40:43], 0 offen nt
  v_add_u32 v8, 4096, v8
  v_and_b32_dpp v20, v50, v4 row_newbcast:9 row_mask:0xf bank_mask:0xf
  v_and_b32_dpp v21, v50, v5 row_newbcast:9 row_mask:0xf bank_mask:0xf
  v_and_b32_dpp v22, v50, v6 row_newbcast:9 row_mask:0xf bank_mask:0xf
  v_and_b32_dpp v23, v50, v7 row_newbcast:9 row_mask:0xf bank_mask:0xf
  v_mfma_f32_16x16x32_bf16 v[24:27], v[16:19], v[224:227], v[24:27]
  s_waitcnt vmcnt(15)
  buffer_load_dwordx4 v[224:227], v8, s[40:43], 0 offen nt
  v_add_u32 v8, 4096, v8
  v_and_b32_dpp v16, v50, v4 row_newbcast:10 row_mask:0xf bank_mask:0xf
  v_and_b32_dpp v17, v50, v5 row_newbcast:10 row_mask:0xf bank_mask:0xf
  v_and_b32_dpp v18, v50, v6 row_newbcast:10 row_mask:0xf bank_mask:0xf
  v_and_b32_dpp v19, v50, v7 row_newbcast:10 row_mask:0xf bank_mask:0xf
  v_mfma_f32_16x16x32_bf16 v[24:27], v[20:23], v[228:231], v[24:27]
  s_waitcnt vmcnt(15)
  buffer_load_dwordx4 v[228:231], v8, s[40:43], 0 offen nt
  v_add_u32 v8, 4096, v8
  v_and_b32_dpp v20, v50, v4 row_newbcast:11 row_mask:0xf bank_mask:0xf
  v_and_b32_dpp v21, v50, v5 row_newbcast:11 row_mask:0xf bank_mask:0xf
  v_and_b32_dpp v22, v50, v6 row_newbcast:11 row_mask:0xf bank_mask:0xf
  v_and_b32_dpp v23, v50, v7 row_newbcast:11 row_mask:0xf bank_mask:0xf
  v_mfma_f32_16x16x32_bf16 v[24:27], v[16:19], v[232:235], v[24:27]
  s_waitcnt vmcnt(15)
  buffer_load_dwordx4 v[232:235], v8, s[40:43], 0 offen nt
  v_add_u32 v8, 4096, v8
  v_and_b32_dpp v16, v50, v4 row_newbcast:12 row_mask:0xf bank_mask:0xf
  v_and_b32_dpp v17, v50, v5 row_newbcast:12 row_mask:0xf bank_mask:0xf
  v_and_b32_dpp v18, v50, v6 row_newbcast:12 row_mask:0xf bank_mask:0xf
  v_and_b32_dpp v19, v50, v7 row_newbcast:12 row_mask:0xf bank_mask:0xf
  v_mfma_f32_16x16x32_bf16 v[24:27], v[20:23], v[236:239], v[24:27]
  s_waitcnt vmcnt(15)
  buffer_load_dwordx4 v[236:239], v8, s[40:43], 0 offen nt
  v_add_u32 v8, 4096, v8
  v_and_b32_dpp v20, v50, v4 row_newbcast:13 row_mask:0xf bank_mask:0xf
  v_and_b32_dpp v21, v50, v5 row_newbcast:13 row_mask:0xf bank_mask:0xf
  v_and_b32_dpp v22, v50, v6 row_newbcast:13 row_mask:0xf bank_mask:0xf
  v_and_b32_dpp v23, v50, v7 row_newbcast:13 row_mask:0xf bank_mask:0xf
  v_mfma_f32_16x16x32_bf16 v[24:27], v[16:19], v[240:243], v[24:27]
  s_waitcnt vmcnt(15)
  buffer_load_dwordx4 v[240:243], v8, s[40:43], 0 offen nt
  v_add_u32 v8, 4096, v8
  v_and_b32_dpp v16, v50, v4 row_newbcast:14 row_mask:0xf bank_mask:0xf
  v_and_b32_dpp v17, v50, v5 row_newbcast:14 row_mask:0xf bank_mask:0xf
  v_and_b32_dpp v18, v50, v6 row_newbcast:14 row_mask:0xf bank_mask:0xf
  v_and_b32_dpp v19, v50, v7 row_newbcast:14 row_mask:0xf bank_mask:0xf
  v_mfma_f32_16x16x32_bf16 v[24:27], v[20:23], v[244:247], v[24:27]
  s_waitcnt vmcnt(15)
  buffer_load_dwordx4 v[244:247], v8, s[40:43], 0 offen nt
  v_add_u32 v8, 4096, v8
  v_and_b32_dpp v20, v50, v4 row_newbcast:15 row_mask:0xf bank_mask:0xf
  v_and_b32_dpp v21, v50, v5 row_newbcast:15 row_mask:0xf bank_mask:0xf
  v_and_b32_dpp v22, v50, v6 row_newbcast:15 row_mask:0xf bank_mask:0xf
  v_and_b32_dpp v23, v50, v7 row_newbcast:15 row_mask:0xf bank_mask:0xf
  v_mfma_f32_16x16x32_bf16 v[24:27], v[16:19], v[248:251], v[24:27]
  s_waitcnt vmcnt(15)
  buffer_load_dwordx4 v[248:251], v8, s[40:43], 0 offen nt
  v_add_u32 v8, 4096, v8
  s_nop 0
  v_mfma_f32_16x16x32_bf16 v[24:27], v[20:23], v[252:255], v[24:27]
  s_waitcnt vmcnt(15)
  buffer_load_dwordx4 v[252:255], v8, s[40:43], 0 offen nt
  v_add_u32 v8, 4096, v8
  s_waitcnt lgkmcnt(0)
  v_subrev_f32 v10, s54, v51
  v_mul_f32 v10, s53, v10
  v_exp_f32 v10, v10
  ds_read_b32 v51, v52 offset:768
  v_add_f32 v49, v49, v10
  v_cvt_pk_bf16_f32 v50, v10, v10
  s_nop 1
  v_and_b32_dpp v16, v50, v4 row_newbcast:0 row_mask:0xf bank_mask:0xf
  v_and_b32_dpp v17, v50, v5 row_newbcast:0 row_mask:0xf bank_mask:0xf
  v_and_b32_dpp v18, v50, v6 row_newbcast:0 row_mask:0xf bank_mask:0xf
  v_and_b32_dpp v19, v50, v7 row_newbcast:0 row_mask:0xf bank_mask:0xf
  v_and_b32_dpp v20, v50, v4 row_newbcast:1 row_mask:0xf bank_mask:0xf
  v_and_b32_dpp v21, v50, v5 row_newbcast:1 row_mask:0xf bank_mask:0xf
  v_and_b32_dpp v22, v50, v6 row_newbcast:1 row_mask:0xf bank_mask:0xf
  v_and_b32_dpp v23, v50, v7 row_newbcast:1 row_mask:0xf bank_mask:0xf
  v_mfma_f32_16x16x32_bf16 v[24:27], v[16:19], v[64:67], v[24:27]
  s_waitcnt vmcnt(15)
  buffer_load_dwordx4 v[64:67], v8, s[40:43], 0 offen nt
  v_add_u32 v8, 4096, v8
  v_and_b32_dpp v16, v50, v4 row_newbcast:2 row_mask:0xf bank_mask:0xf
  v_and_b32_dpp v17, v50, v5 row_newbcast:2 row_mask:0xf bank_mask:0xf
  v_and_b32_dpp v18, v50, v6 row_newbcast:2 row_mask:0xf bank_mask:0xf
  v_and_b32_dpp v19, v50, v7 row_newbcast:2 row_mask:0xf bank_mask:0xf
  v_mfma_f32_16x16x32_bf16 v[24:27], v[20:23], v[68:71], v[24:27]
  s_waitcnt vmcnt(15)
  buffer_load_dwordx4 v[68:71], v8, s[40:43], 0 offen nt
  v_add_u32 v8, 4096, v8
  v_and_b32_dpp v20, v50, v4 row_newbcast:3 row_mask:0xf bank_mask:0xf
  v_and_b32_dpp v21, v50, v5 row_newbcast:3 row_mask:0xf bank_mask:0xf
  v_and_b32_dpp v22, v50, v6 row_newbcast:3 row_mask:0xf bank_mask:0xf
  v_and_b32_dpp v23, v50, v7 row_newbcast:3 row_mask:0xf bank_mask:0xf
  v_mfma_f32_16x16x32_bf16 v[24:27], v[16:19], v[72:75], v[24:27]
  s_waitcnt vmcnt(15)
  buffer_load_dwordx4 v[72:75], v8, s[40:43], 0 offen nt
  v_add_u32 v8, 4096, v8
  v_and_b32_dpp v16, v50, v4 row_newbcast:4 row_mask:0xf bank_mask:0xf
  v_and_b32_dpp v17, v50, v5 row_newbcast:4 row_mask:0xf bank_mask:0xf
  v_and_b32_dpp v18, v50, v6 row_newbcast:4 row_mask:0xf bank_mask:0xf
  v_and_b32_dpp v19, v50, v7 row_newbcast:4 row_mask:0xf bank_mask:0xf
  v_mfma_f32_16x16x32_bf16 v[24:27], v[20:23], v[76:79], v[24:27]
  s_waitcnt vmcnt(15)
  buffer_load_dwordx4 v[76:79], v8, s[40:43], 0 offen nt
  v_add_u32 v8, 4096, v8
  v_and_b32_dpp v20, v50, v4 row_newbcast:5 row_mask:0xf bank_mask:0xf
  v_and_b32_dpp v21, v50, v5 row_newbcast:5 row_mask:0xf bank_mask:0xf
  v_and_b32_dpp v22, v50, v6 row_newbcast:5 row_mask:0xf bank_mask:0xf
  v_and_b32_dpp v23, v50, v7 row_newbcast:5 row_mask:0xf bank_mask:0xf
  v_mfma_f32_16x16x32_bf16 v[24:27], v[16:19], v[80:83], v[24:27]
  s_waitcnt vmcnt(15)
  buffer_load_dwordx4 v[80:83], v8, s[40:43], 0 offen nt
  v_add_u32 v8, 4096, v8
  v_and_b32_dpp v16, v50, v4 row_newbcast:6 row_mask:0xf bank_mask:0xf
  v_and_b32_dpp v17, v50, v5 row_newbcast:6 row_mask:0xf bank_mask:0xf
  v_and_b32_dpp v18, v50, v6 row_newbcast:6 row_mask:0xf bank_mask:0xf
  v_and_b32_dpp v19, v50, v7 row_newbcast:6 row_mask:0xf bank_mask:0xf
  v_mfma_f32_16x16x32_bf16 v[24:27], v[20:23], v[84:87], v[24:27]
  s_waitcnt vmcnt(15)
  buffer_load_dwordx4 v[84:87], v8, s[40:43], 0 offen nt
  v_add_u32 v8, 4096, v8
  v_and_b32_dpp v20, v50, v4 row_newbcast:7 row_mask:0xf bank_mask:0xf
  v_and_b32_dpp v21, v50, v5 row_newbcast:7 row_mask:0xf bank_mask:0xf
  v_and_b32_dpp v22, v50, v6 row_newbcast:7 row_mask:0xf bank_mask:0xf
  v_and_b32_dpp v23, v50, v7 row_newbcast:7 row_mask:0xf bank_mask:0xf
  v_mfma_f32_16x16x32_bf16 v[24:27], v[16:19], v[88:91], v[24:27]
  s_waitcnt vmcnt(15)
  buffer_load_dwordx4 v[88:91], v8, s[40:43], 0 offen nt
  v_add_u32 v8, 4096, v8
  v_and_b32_dpp v16, v50, v4 row_newbcast:8 row_mask:0xf bank_mask:0xf
  v_and_b32_dpp v17, v50, v5 row_newbcast:8 row_mask:0xf bank_mask:0xf
  v_and_b32_dpp v18, v50, v6 row_newbcast:8 row_mask:0xf bank_mask:0xf
  v_and_b32_dpp v19, v50, v7 row_newbcast:8 row_mask:0xf bank_mask:0xf
  v_mfma_f32_16x16x32_bf16 v[24:27], v[20:23], v[92:95], v[24:27]
  s_waitcnt vmcnt(15)
  buffer_load_dwordx4 v[92:95], v8, s[40:43], 0 offen nt
  v_add_u32 v8, 4096, v8
  v_and_b32_dpp v20, v50, v4 row_newbcast:9 row_mask:0xf bank_mask:0xf
  v_and_b32_dpp v21, v50, v5 row_newbcast:9 row_mask:0xf bank_mask:0xf
  v_and_b32_dpp v22, v50, v6 row_newbcast:9 row_mask:0xf bank_mask:0xf
  v_and_b32_dpp v23, v50, v7 row_newbcast:9 row_mask:0xf bank_mask:0xf
  v_mfma_f32_16x16x32_bf16 v[24:27], v[16:19], v[96:99], v[24:27]
  s_waitcnt vmcnt(15)
  buffer_load_dwordx4 v[96:99], v8, s[40:43], 0 offen nt
  v_add_u32 v8, 4096, v8
  v_and_b32_dpp v16, v50, v4 row_newbcast:10 row_mask:0xf bank_mask:0xf
  v_and_b32_dpp v17, v50, v5 row_newbcast:10 row_mask:0xf bank_mask:0xf
  v_and_b32_dpp v18, v50, v6 row_newbcast:10 row_mask:0xf bank_mask:0xf
  v_and_b32_dpp v19, v50, v7 row_newbcast:10 row_mask:0xf bank_mask:0xf
  v_mfma_f32_16x16x32_bf16 v[24:27], v[20:23], v[100:103], v[24:27]
  s_waitcnt vmcnt(15)
  buffer_load_dwordx4 v[100:103], v8, s[40:43], 0 offen nt
  v_add_u32 v8, 4096, v8
  v_and_b32_dpp v20, v50, v4 row_newbcast:11 row_mask:0xf bank_mask:0xf
  v_and_b32_dpp v21, v50, v5 row_newbcast:11 row_mask:0xf bank_mask:0xf
  v_and_b32_dpp v22, v50, v6 row_newbcast:11 row_mask:0xf bank_mask:0xf
  v_and_b32_dpp v23, v50, v7 row_newbcast:11 row_mask:0xf bank_mask:0xf
  v_mfma_f32_16x16x32_bf16 v[24:27], v[16:19], v[104:107], v[24:27]
  s_waitcnt vmcnt(15)
  buffer_load_dwordx4 v[104:107], v8, s[40:43], 0 offen nt
  v_add_u32 v8, 4096, v8
  v_and_b32_dpp v16, v50, v4 row_newbcast:12 row_mask:0xf bank_mask:0xf
  v_and_b32_dpp v17, v50, v5 row_newbcast:12 row_mask:0xf bank_mask:0xf
  v_and_b32_dpp v18, v50, v6 row_newbcast:12 row_mask:0xf bank_mask:0xf
  v_and_b32_dpp v19, v50, v7 row_newbcast:12 row_mask:0xf bank_mask:0xf
  v_mfma_f32_16x16x32_bf16 v[24:27], v[20:23], v[108:111], v[24:27]
  s_waitcnt vmcnt(15)
  buffer_load_dwordx4 v[108:111], v8, s[40:43], 0 offen nt
  v_add_u32 v8, 4096, v8
  v_and_b32_dpp v20, v50, v4 row_newbcast:13 row_mask:0xf bank_mask:0xf
  v_and_b32_dpp v21, v50, v5 row_newbcast:13 row_mask:0xf bank_mask:0xf
  v_and_b32_dpp v22, v50, v6 row_newbcast:13 row_mask:0xf bank_mask:0xf
  v_and_b32_dpp v23, v50, v7 row_newbcast:13 row_mask:0xf bank_mask:0xf
  v_mfma_f32_16x16x32_bf16 v[24:27], v[16:19], v[112:115], v[24:27]
  s_waitcnt vmcnt(15)
  buffer_load_dwordx4 v[112:115], v8, s[40:43], 0 offen nt
  v_add_u32 v8, 4096, v8
  v_and_b32_dpp v16, v50, v4 row_newbcast:14 row_mask:0xf bank_mask:0xf
  v_and_b32_dpp v17, v50, v5 row_newbcast:14 row_mask:0xf bank_mask:0xf
  v_and_b32_dpp v18, v50, v6 row_newbcast:14 row_mask:0xf bank_mask:0xf
  v_and_b32_dpp v19, v50, v7 row_newbcast:14 row_mask:0xf bank_mask:0xf
  v_mfma_f32_16x16x32_bf16 v[24:27], v[20:23], v[116:119], v[24:27]
  s_waitcnt vmcnt(15)
  buffer_load_dwordx4 v[116:119], v8, s[40:43], 0 offen nt
  v_add_u32 v8, 4096, v8
  v_and_b32_dpp v20, v50, v4 row_newbcast:15 row_mask:0xf bank_mask:0xf
  v_and_b32_dpp v21, v50, v5 row_newbcast:15 row_mask:0xf bank_mask:0xf
  v_and_b32_dpp v22, v50, v6 row_newbcast:15 row_mask:0xf bank_mask:0xf
  v_and_b32_dpp v23, v50, v7 row_newbcast:15 row_mask:0xf bank_mask:0xf
  v_mfma_f32_16x16x32_bf16 v[24:27], v[16:19], v[120:123], v[24:27]
  s_waitcnt vmcnt(15)
  buffer_load_dwordx4 v[120:123], v8, s[40:43], 0 offen nt
  v_add_u32 v8, 4096, v8
  s_nop 0
  v_mfma_f32_16x16x32_bf16 v[24:27], v[20:23], v[124:127], v[24:27]
  s_waitcnt vmcnt(15)
  buffer_load_dwordx4 v[124:127], v8, s[40:43], 0 offen nt
  v_add_u32 v8, 4096, v8
  s_waitcnt lgkmcnt(0)
  v_subrev_f32 v10, s54, v51
  v_mul_f32 v10, s53, v10
  v_exp_f32 v10, v10
  ds_read_b32 v51, v52 offset:1024
  v_add_f32 v49, v49, v10
  v_cvt_pk_bf16_f32 v50, v10, v10
  s_nop 1
  v_and_b32_dpp v16, v50, v4 row_newbcast:0 row_mask:0xf bank_mask:0xf
  v_and_b32_dpp v17, v50, v5 row_newbcast:0 row_mask:0xf bank_mask:0xf
  v_and_b32_dpp v18, v50, v6 row_newbcast:0 row_mask:0xf bank_mask:0xf
  v_and_b32_dpp v19, v50, v7 row_newbcast:0 row_mask:0xf bank_mask:0xf
  v_and_b32_dpp v20, v50, v4 row_newbcast:1 row_mask:0xf bank_mask:0xf
  v_and_b32_dpp v21, v50, v5 row_newbcast:1 row_mask:0xf bank_mask:0xf
  v_and_b32_dpp v22, v50, v6 row_newbcast:1 row_mask:0xf bank_mask:0xf
  v_and_b32_dpp v23, v50, v7 row_newbcast:1 row_mask:0xf bank_mask:0xf
  v_mfma_f32_16x16x32_bf16 v[24:27], v[16:19], v[128:131], v[24:27]
  s_waitcnt vmcnt(15)
  buffer_load_dwordx4 v[128:131], v8, s[40:43], 0 offen nt
  v_add_u32 v8, 4096, v8
  v_and_b32_dpp v16, v50, v4 row_newbcast:2 row_mask:0xf bank_mask:0xf
  v_and_b32_dpp v17, v50, v5 row_newbcast:2 row_mask:0xf bank_mask:0xf
  v_and_b32_dpp v18, v50, v6 row_newbcast:2 row_mask:0xf bank_mask:0xf
  v_and_b32_dpp v19, v50, v7 row_newbcast:2 row_mask:0xf bank_mask:0xf
  v_mfma_f32_16x16x32_bf16 v[24:27], v[20:23], v[132:135], v[24:27]
  s_waitcnt vmcnt(15)
  buffer_load_dwordx4 v[132:135], v8, s[40:43], 0 offen nt
  v_add_u32 v8, 4096, v8
  v_and_b32_dpp v20, v50, v4 row_newbcast:3 row_mask:0xf bank_mask:0xf
  v_and_b32_dpp v21, v50, v5 row_newbcast:3 row_mask:0xf bank_mask:0xf
  v_and_b32_dpp v22, v50, v6 row_newbcast:3 row_mask:0xf bank_mask:0xf
  v_and_b32_dpp v23, v50, v7 row_newbcast:3 row_mask:0xf bank_mask:0xf
  v_mfma_f32_16x16x32_bf16 v[24:27], v[16:19], v[136:139], v[24:27]
  s_waitcnt vmcnt(15)
  buffer_load_dwordx4 v[136:139], v8, s[40:43], 0 offen nt
  v_add_u32 v8, 4096, v8
  v_and_b32_dpp v16, v50, v4 row_newbcast:4 row_mask:0xf bank_mask:0xf
  v_and_b32_dpp v17, v50, v5 row_newbcast:4 row_mask:0xf bank_mask:0xf
  v_and_b32_dpp v18, v50, v6 row_newbcast:4 row_mask:0xf bank_mask:0xf
  v_and_b32_dpp v19, v50, v7 row_newbcast:4 row_mask:0xf bank_mask:0xf
  v_mfma_f32_16x16x32_bf16 v[24:27], v[20:23], v[140:143], v[24:27]
  s_waitcnt vmcnt(15)
  buffer_load_dwordx4 v[140:143], v8, s[40:43], 0 offen nt
  v_add_u32 v8, 4096, v8
  v_and_b32_dpp v20, v50, v4 row_newbcast:5 row_mask:0xf bank_mask:0xf
  v_and_b32_dpp v21, v50, v5 row_newbcast:5 row_mask:0xf bank_mask:0xf
  v_and_b32_dpp v22, v50, v6 row_newbcast:5 row_mask:0xf bank_mask:0xf
  v_and_b32_dpp v23, v50, v7 row_newbcast:5 row_mask:0xf bank_mask:0xf
  v_mfma_f32_16x16x32_bf16 v[24:27], v[16:19], v[144:147], v[24:27]
  s_waitcnt vmcnt(15)
  buffer_load_dwordx4 v[144:147], v8, s[40:43], 0 offen nt
  v_add_u32 v8, 4096, v8
  v_and_b32_dpp v16, v50, v4 row_newbcast:6 row_mask:0xf bank_mask:0xf
  v_and_b32_dpp v17, v50, v5 row_newbcast:6 row_mask:0xf bank_mask:0xf
  v_and_b32_dpp v18, v50, v6 row_newbcast:6 row_mask:0xf bank_mask:0xf
  v_and_b32_dpp v19, v50, v7 row_newbcast:6 row_mask:0xf bank_mask:0xf
  v_mfma_f32_16x16x32_bf16 v[24:27], v[20:23], v[148:151], v[24:27]
  s_waitcnt vmcnt(15)
  buffer_load_dwordx4 v[148:151], v8, s[40:43], 0 offen nt
  v_add_u32 v8, 4096, v8
  v_and_b32_dpp v20, v50, v4 row_newbcast:7 row_mask:0xf bank_mask:0xf
  v_and_b32_dpp v21, v50, v5 row_newbcast:7 row_mask:0xf bank_mask:0xf
  v_and_b32_dpp v22, v50, v6 row_newbcast:7 row_mask:0xf bank_mask:0xf
  v_and_b32_dpp v23, v50, v7 row_newbcast:7 row_mask:0xf bank_mask:0xf
  v_mfma_f32_16x16x32_bf16 v[24:27], v[16:19], v[152:155], v[24:27]
  s_waitcnt vmcnt(15)
  buffer_load_dwordx4 v[152:155], v8, s[40:43], 0 offen nt
  v_add_u32 v8, 4096, v8
  v_and_b32_dpp v16, v50, v4 row_newbcast:8 row_mask:0xf bank_mask:0xf
  v_and_b32_dpp v17, v50, v5 row_newbcast:8 row_mask:0xf bank_mask:0xf
  v_and_b32_dpp v18, v50, v6 row_newbcast:8 row_mask:0xf bank_mask:0xf
  v_and_b32_dpp v19, v50, v7 row_newbcast:8 row_mask:0xf bank_mask:0xf
  v_mfma_f32_16x16x32_bf16 v[24:27], v[20:23], v[156:159], v[24:27]
  s_waitcnt vmcnt(15)
  buffer_load_dwordx4 v[156:159], v8, s[40:43], 0 offen nt
  v_add_u32 v8, 4096, v8
  v_and_b32_dpp v20, v50, v4 row_newbcast:9 row_mask:0xf bank_mask:0xf
  v_and_b32_dpp v21, v50, v5 row_newbcast:9 row_mask:0xf bank_mask:0xf
  v_and_b32_dpp v22, v50, v6 row_newbcast:9 row_mask:0xf bank_mask:0xf
  v_and_b32_dpp v23, v50, v7 row_newbcast:9 row_mask:0xf bank_mask:0xf
  v_mfma_f32_16x16x32_bf16 v[24:27], v[16:19], v[160:163], v[24:27]
  s_waitcnt vmcnt(15)
  buffer_load_dwordx4 v[160:163], v8, s[40:43], 0 offen nt
  v_add_u32 v8, 4096, v8
  v_and_b32_dpp v16, v50, v4 row_newbcast:10 row_mask:0xf bank_mask:0xf
  v_and_b32_dpp v17, v50, v5 row_newbcast:10 row_mask:0xf bank_mask:0xf
  v_and_b32_dpp v18, v50, v6 row_newbcast:10 row_mask:0xf bank_mask:0xf
  v_and_b32_dpp v19, v50, v7 row_newbcast:10 row_mask:0xf bank_mask:0xf
  v_mfma_f32_16x16x32_bf16 v[24:27], v[20:23], v[164:167], v[24:27]
  s_waitcnt vmcnt(15)
  buffer_load_dwordx4 v[164:167], v8, s[40:43], 0 offen nt
  v_add_u32 v8, 4096, v8
  v_and_b32_dpp v20, v50, v4 row_newbcast:11 row_mask:0xf bank_mask:0xf
  v_and_b32_dpp v21, v50, v5 row_newbcast:11 row_mask:0xf bank_mask:0xf
  v_and_b32_dpp v22, v50, v6 row_newbcast:11 row_mask:0xf bank_mask:0xf
  v_and_b32_dpp v23, v50, v7 row_newbcast:11 row_mask:0xf bank_mask:0xf
  v_mfma_f32_16x16x32_bf16 v[24:27], v[16:19], v[168:171], v[24:27]
  s_waitcnt vmcnt(15)
  buffer_load_dwordx4 v[168:171], v8, s[40:43], 0 offen nt
  v_add_u32 v8, 4096, v8
  v_and_b32_dpp v16, v50, v4 row_newbcast:12 row_mask:0xf bank_mask:0xf
  v_and_b32_dpp v17, v50, v5 row_newbcast:12 row_mask:0xf bank_mask:0xf
  v_and_b32_dpp v18, v50, v6 row_newbcast:12 row_mask:0xf bank_mask:0xf
  v_and_b32_dpp v19, v50, v7 row_newbcast:12 row_mask:0xf bank_mask:0xf
  v_mfma_f32_16x16x32_bf16 v[24:27], v[20:23], v[172:175], v[24:27]
  s_waitcnt vmcnt(15)
  buffer_load_dwordx4 v[172:175], v8, s[40:43], 0 offen nt
  v_add_u32 v8, 4096, v8
  v_and_b32_dpp v20, v50, v4 row_newbcast:13 row_mask:0xf bank_mask:0xf
  v_and_b32_dpp v21, v50, v5 row_newbcast:13 row_mask:0xf bank_mask:0xf
  v_and_b32_dpp v22, v50, v6 row_newbcast:13 row_mask:0xf bank_mask:0xf
  v_and_b32_dpp v23, v50, v7 row_newbcast:13 row_mask:0xf bank_mask:0xf
  v_mfma_f32_16x16x32_bf16 v[24:27], v[16:19], v[176:179], v[24:27]
  s_waitcnt vmcnt(15)
  buffer_load_dwordx4 v[176:179], v8, s[40:43], 0 offen nt
  v_add_u32 v8, 4096, v8
  v_and_b32_dpp v16, v50, v4 row_newbcast:14 row_mask:0xf bank_mask:0xf
  v_and_b32_dpp v17, v50, v5 row_newbcast:14 row_mask:0xf bank_mask:0xf
  v_and_b32_dpp v18, v50, v6 row_newbcast:14 row_mask:0xf bank_mask:0xf
  v_and_b32_dpp v19, v50, v7 row_newbcast:14 row_mask:0xf bank_mask:0xf
  v_mfma_f32_16x16x32_bf16 v[24:27], v[20:23], v[180:183], v[24:27]
  s_waitcnt vmcnt(15)
  buffer_load_dwordx4 v[180:183], v8, s[40:43], 0 offen nt
  v_add_u32 v8, 4096, v8
  v_and_b32_dpp v20, v50, v4 row_newbcast:15 row_mask:0xf bank_mask:0xf
  v_and_b32_dpp v21, v50, v5 row_newbcast:15 row_mask:0xf bank_mask:0xf
  v_and_b32_dpp v22, v50, v6 row_newbcast:15 row_mask:0xf bank_mask:0xf
  v_and_b32_dpp v23, v50, v7 row_newbcast:15 row_mask:0xf bank_mask:0xf
  v_mfma_f32_16x16x32_bf16 v[24:27], v[16:19], v[184:187], v[24:27]
  s_waitcnt vmcnt(15)
  buffer_load_dwordx4 v[184:187], v8, s[40:43], 0 offen nt
  v_add_u32 v8, 4096, v8
  s_nop 0
  v_mfma_f32_16x16x32_bf16 v[24:27], v[20:23], v[188:191], v[24:27]
  s_waitcnt vmcnt(15)
  buffer_load_dwordx4 v[188:191], v8, s[40:43], 0 offen nt
  v_add_u32 v8, 4096, v8
  ds_read_b32 v33, v52 offset:1280
  ds_read_b32 v34, v52 offset:1536
  s_waitcnt lgkmcnt(0)
  v_mov_b32 v32, v51
  v_subrev_f32 v32, s54, v32
  v_subrev_f32 v33, s54, v33
  v_subrev_f32 v34, s54, v34
  v_mul_f32 v32, s53, v32
  v_mul_f32 v33, s53, v33
  v_mul_f32 v34, s53, v34
  v_exp_f32 v32, v32
  v_exp_f32 v33, v33
  v_exp_f32 v34, v34
  s_nop 0
  v_add_f32 v49, v49, v32
  v_add_f32 v49, v49, v33
  v_add_f32 v49, v49, v34
  v_cvt_pk_bf16_f32 v32, v32, v32
  v_cvt_pk_bf16_f32 v33, v33, v33
  v_cvt_pk_bf16_f32 v34, v34, v34
  v_add_f32_dpp v49, v49, v49 row_ror:8 row_mask:0xf bank_mask:0xf
  v_lshlrev_b32 v55, 5, v3
  v_lshlrev_b32 v11, 4, v2
  v_add_f32_dpp v49, v49, v49 row_ror:4 row_mask:0xf bank_mask:0xf
  v_add_u32 v55, v55, v11
  s_lshl_b32 s50, s30, 9
  v_add_f32_dpp v49, v49, v49 row_ror:2 row_mask:0xf bank_mask:0xf
  v_add_u32 v55, s50, v55
  s_lshl_b32 s50, s30, 3
  v_add_f32_dpp v49, v49, v49 row_ror:1 row_mask:0xf bank_mask:0xf
  v_mov_b32 v12, s50
  v_mov_b32 v14, s54
  v_add_f32_dpp v49, v49, v49 row_bcast:15 row_mask:0xa bank_mask:0xf
  v_mov_b32 v10, 6404
  v_mov_b32 v11, 1
  v_add_f32_dpp v49, v49, v49 row_bcast:31 row_mask:0xc bank_mask:0xf
  s_waitcnt vmcnt(16)
  ds_write_b32 v12, v53 offset:6176
  v_readlane_b32 s51, v49, 63
  s_nop 1
  v_mov_b32 v15, s51
  ds_write_b64 v12, v[14:15] offset:6144
  s_waitcnt lgkmcnt(0)
  s_mov_b64 exec, 1
  ds_add_u32 v10, v11
  s_mov_b64 exec, -1
  s_nop 3
  v_and_b32_dpp v16, v32, v4 row_newbcast:0 row_mask:0xf bank_mask:0xf
  v_and_b32_dpp v17, v32, v5 row_newbcast:0 row_mask:0xf bank_mask:0xf
  v_and_b32_dpp v18, v32, v6 row_newbcast:0 row_mask:0xf bank_mask:0xf
  v_and_b32_dpp v19, v32, v7 row_newbcast:0 row_mask:0xf bank_mask:0xf
  v_and_b32_dpp v20, v32, v4 row_newbcast:1 row_mask:0xf bank_mask:0xf
  v_and_b32_dpp v21, v32, v5 row_newbcast:1 row_mask:0xf bank_mask:0xf
  v_and_b32_dpp v22, v32, v6 row_newbcast:1 row_mask:0xf bank_mask:0xf
  v_and_b32_dpp v23, v32, v7 row_newbcast:1 row_mask:0xf bank_mask:0xf
  v_mfma_f32_16x16x32_bf16 v[24:27], v[16:19], v[192:195], v[24:27]
  v_and_b32_dpp v16, v32, v4 row_newbcast:2 row_mask:0xf bank_mask:0xf
  v_and_b32_dpp v17, v32, v5 row_newbcast:2 row_mask:0xf bank_mask:0xf
  v_and_b32_dpp v18, v32, v6 row_newbcast:2 row_mask:0xf bank_mask:0xf
  v_and_b32_dpp v19, v32, v7 row_newbcast:2 row_mask:0xf bank_mask:0xf
  v_mfma_f32_16x16x32_bf16 v[24:27], v[20:23], v[196:199], v[24:27]
  v_and_b32_dpp v20, v32, v4 row_newbcast:3 row_mask:0xf bank_mask:0xf
  v_and_b32_dpp v21, v32, v5 row_newbcast:3 row_mask:0xf bank_mask:0xf
  v_and_b32_dpp v22, v32, v6 row_newbcast:3 row_mask:0xf bank_mask:0xf
  v_and_b32_dpp v23, v32, v7 row_newbcast:3 row_mask:0xf bank_mask:0xf
  v_mfma_f32_16x16x32_bf16 v[24:27], v[16:19], v[200:203], v[24:27]
  v_and_b32_dpp v16, v32, v4 row_newbcast:4 row_mask:0xf bank_mask:0xf
  v_and_b32_dpp v17, v32, v5 row_newbcast:4 row_mask:0xf bank_mask:0xf
  v_and_b32_dpp v18, v32, v6 row_newbcast:4 row_mask:0xf bank_mask:0xf
  v_and_b32_dpp v19, v32, v7 row_newbcast:4 row_mask:0xf bank_mask:0xf
  v_mfma_f32_16x16x32_bf16 v[24:27], v[20:23], v[204:207], v[24:27]
  v_and_b32_dpp v20, v32, v4 row_newbcast:5 row_mask:0xf bank_mask:0xf
  v_and_b32_dpp v21, v32, v5 row_newbcast:5 row_mask:0xf bank_mask:0xf
  v_and_b32_dpp v22, v32, v6 row_newbcast:5 row_mask:0xf bank_mask:0xf
  v_and_b32_dpp v23, v32, v7 row_newbcast:5 row_mask:0xf bank_mask:0xf
  v_mfma_f32_16x16x32_bf16 v[24:27], v[16:19], v[208:211], v[24:27]
  v_and_b32_dpp v16, v32, v4 row_newbcast:6 row_mask:0xf bank_mask:0xf
  v_and_b32_dpp v17, v32, v5 row_newbcast:6 row_mask:0xf bank_mask:0xf
  v_and_b32_dpp v18, v32, v6 row_newbcast:6 row_mask:0xf bank_mask:0xf
  v_and_b32_dpp v19, v32, v7 row_newbcast:6 row_mask:0xf bank_mask:0xf
  v_mfma_f32_16x16x32_bf16 v[24:27], v[20:23], v[212:215], v[24:27]
  v_and_b32_dpp v20, v32, v4 row_newbcast:7 row_mask:0xf bank_mask:0xf
  v_and_b32_dpp v21, v32, v5 row_newbcast:7 row_mask:0xf bank_mask:0xf
  v_and_b32_dpp v22, v32, v6 row_newbcast:7 row_mask:0xf bank_mask:0xf
  v_and_b32_dpp v23, v32, v7 row_newbcast:7 row_mask:0xf bank_mask:0xf
  v_mfma_f32_16x16x32_bf16 v[24:27], v[16:19], v[216:219], v[24:27]
  v_and_b32_dpp v16, v32, v4 row_newbcast:8 row_mask:0xf bank_mask:0xf
  v_and_b32_dpp v17, v32, v5 row_newbcast:8 row_mask:0xf bank_mask:0xf
  v_and_b32_dpp v18, v32, v6 row_newbcast:8 row_mask:0xf bank_mask:0xf
  v_and_b32_dpp v19, v32, v7 row_newbcast:8 row_mask:0xf bank_mask:0xf
  v_mfma_f32_16x16x32_bf16 v[24:27], v[20:23], v[220:223], v[24:27]
  v_and_b32_dpp v20, v32, v4 row_newbcast:9 row_mask:0xf bank_mask:0xf
  v_and_b32_dpp v21, v32, v5 row_newbcast:9 row_mask:0xf bank_mask:0xf
  v_and_b32_dpp v22, v32, v6 row_newbcast:9 row_mask:0xf bank_mask:0xf
  v_and_b32_dpp v23, v32, v7 row_newbcast:9 row_mask:0xf bank_mask:0xf
  v_mfma_f32_16x16x32_bf16 v[24:27], v[16:19], v[224:227], v[24:27]
  v_and_b32_dpp v16, v32, v4 row_newbcast:10 row_mask:0xf bank_mask:0xf
  v_and_b32_dpp v17, v32, v5 row_newbcast:10 row_mask:0xf bank_mask:0xf
  v_and_b32_dpp v18, v32, v6 row_newbcast:10 row_mask:0xf bank_mask:0xf
  v_and_b32_dpp v19, v32, v7 row_newbcast:10 row_mask:0xf bank_mask:0xf
  v_mfma_f32_16x16x32_bf16 v[24:27], v[20:23], v[228:231], v[24:27]
  v_and_b32_dpp v20, v32, v4 row_newbcast:11 row_mask:0xf bank_mask:0xf
  v_and_b32_dpp v21, v32, v5 row_newbcast:11 row_mask:0xf bank_mask:0xf
  v_and_b32_dpp v22, v32, v6 row_newbcast:11 row_mask:0xf bank_mask:0xf
  v_and_b32_dpp v23, v32, v7 row_newbcast:11 row_mask:0xf bank_mask:0xf
  v_mfma_f32_16x16x32_bf16 v[24:27], v[16:19], v[232:235], v[24:27]
  v_and_b32_dpp v16, v32, v4 row_newbcast:12 row_mask:0xf bank_mask:0xf
  v_and_b32_dpp v17, v32, v5 row_newbcast:12 row_mask:0xf bank_mask:0xf
  v_and_b32_dpp v18, v32, v6 row_newbcast:12 row_mask:0xf bank_mask:0xf
  v_and_b32_dpp v19, v32, v7 row_newbcast:12 row_mask:0xf bank_mask:0xf
  v_mfma_f32_16x16x32_bf16 v[24:27], v[20:23], v[236:239], v[24:27]
  v_and_b32_dpp v20, v32, v4 row_newbcast:13 row_mask:0xf bank_mask:0xf
  v_and_b32_dpp v21, v32, v5 row_newbcast:13 row_mask:0xf bank_mask:0xf
  v_and_b32_dpp v22, v32, v6 row_newbcast:13 row_mask:0xf bank_mask:0xf
  v_and_b32_dpp v23, v32, v7 row_newbcast:13 row_mask:0xf bank_mask:0xf
  v_mfma_f32_16x16x32_bf16 v[24:27], v[16:19], v[240:243], v[24:27]
  v_and_b32_dpp v16, v32, v4 row_newbcast:14 row_mask:0xf bank_mask:0xf
  v_and_b32_dpp v17, v32, v5 row_newbcast:14 row_mask:0xf bank_mask:0xf
  v_and_b32_dpp v18, v32, v6 row_newbcast:14 row_mask:0xf bank_mask:0xf
  v_and_b32_dpp v19, v32, v7 row_newbcast:14 row_mask:0xf bank_mask:0xf
  v_mfma_f32_16x16x32_bf16 v[24:27], v[20:23], v[244:247], v[24:27]
  v_and_b32_dpp v20, v32, v4 row_newbcast:15 row_mask:0xf bank_mask:0xf
  v_and_b32_dpp v21, v32, v5 row_newbcast:15 row_mask:0xf bank_mask:0xf
  v_and_b32_dpp v22, v32, v6 row_newbcast:15 row_mask:0xf bank_mask:0xf
  v_and_b32_dpp v23, v32, v7 row_newbcast:15 row_mask:0xf bank_mask:0xf
  v_mfma_f32_16x16x32_bf16 v[24:27], v[16:19], v[248:251], v[24:27]
  s_nop 0
  v_mfma_f32_16x16x32_bf16 v[24:27], v[20:23], v[252:255], v[24:27]
  v_and_b32_dpp v16, v33, v4 row_newbcast:0 row_mask:0xf bank_mask:0xf
  v_and_b32_dpp v17, v33, v5 row_newbcast:0 row_mask:0xf bank_mask:0xf
  v_and_b32_dpp v18, v33, v6 row_newbcast:0 row_mask:0xf bank_mask:0xf
  v_and_b32_dpp v19, v33, v7 row_newbcast:0 row_mask:0xf bank_mask:0xf
  v_and_b32_dpp v20, v33, v4 row_newbcast:1 row_mask:0xf bank_mask:0xf
  v_and_b32_dpp v21, v33, v5 row_newbcast:1 row_mask:0xf bank_mask:0xf
  v_and_b32_dpp v22, v33, v6 row_newbcast:1 row_mask:0xf bank_mask:0xf
  v_and_b32_dpp v23, v33, v7 row_newbcast:1 row_mask:0xf bank_mask:0xf
  v_mfma_f32_16x16x32_bf16 v[24:27], v[16:19], v[64:67], v[24:27]
  v_and_b32_dpp v16, v33, v4 row_newbcast:2 row_mask:0xf bank_mask:0xf
  v_and_b32_dpp v17, v33, v5 row_newbcast:2 row_mask:0xf bank_mask:0xf
  v_and_b32_dpp v18, v33, v6 row_newbcast:2 row_mask:0xf bank_mask:0xf
  v_and_b32_dpp v19, v33, v7 row_newbcast:2 row_mask:0xf bank_mask:0xf
  v_mfma_f32_16x16x32_bf16 v[24:27], v[20:23], v[68:71], v[24:27]
  v_and_b32_dpp v20, v33, v4 row_newbcast:3 row_mask:0xf bank_mask:0xf
  v_and_b32_dpp v21, v33, v5 row_newbcast:3 row_mask:0xf bank_mask:0xf
  v_and_b32_dpp v22, v33, v6 row_newbcast:3 row_mask:0xf bank_mask:0xf
  v_and_b32_dpp v23, v33, v7 row_newbcast:3 row_mask:0xf bank_mask:0xf
  v_mfma_f32_16x16x32_bf16 v[24:27], v[16:19], v[72:75], v[24:27]
  v_and_b32_dpp v16, v33, v4 row_newbcast:4 row_mask:0xf bank_mask:0xf
  v_and_b32_dpp v17, v33, v5 row_newbcast:4 row_mask:0xf bank_mask:0xf
  v_and_b32_dpp v18, v33, v6 row_newbcast:4 row_mask:0xf bank_mask:0xf
  v_and_b32_dpp v19, v33, v7 row_newbcast:4 row_mask:0xf bank_mask:0xf
  v_mfma_f32_16x16x32_bf16 v[24:27], v[20:23], v[76:79], v[24:27]
  v_and_b32_dpp v20, v33, v4 row_newbcast:5 row_mask:0xf bank_mask:0xf
  v_and_b32_dpp v21, v33, v5 row_newbcast:5 row_mask:0xf bank_mask:0xf
  v_and_b32_dpp v22, v33, v6 row_newbcast:5 row_mask:0xf bank_mask:0xf
  v_and_b32_dpp v23, v33, v7 row_newbcast:5 row_mask:0xf bank_mask:0xf
  v_mfma_f32_16x16x32_bf16 v[24:27], v[16:19], v[80:83], v[24:27]
  v_and_b32_dpp v16, v33, v4 row_newbcast:6 row_mask:0xf bank_mask:0xf
  v_and_b32_dpp v17, v33, v5 row_newbcast:6 row_mask:0xf bank_mask:0xf
  v_and_b32_dpp v18, v33, v6 row_newbcast:6 row_mask:0xf bank_mask:0xf
  v_and_b32_dpp v19, v33, v7 row_newbcast:6 row_mask:0xf bank_mask:0xf
  v_mfma_f32_16x16x32_bf16 v[24:27], v[20:23], v[84:87], v[24:27]
  v_and_b32_dpp v20, v33, v4 row_newbcast:7 row_mask:0xf bank_mask:0xf
  v_and_b32_dpp v21, v33, v5 row_newbcast:7 row_mask:0xf bank_mask:0xf
  v_and_b32_dpp v22, v33, v6 row_newbcast:7 row_mask:0xf bank_mask:0xf
  v_and_b32_dpp v23, v33, v7 row_newbcast:7 row_mask:0xf bank_mask:0xf
  v_mfma_f32_16x16x32_bf16 v[24:27], v[16:19], v[88:91], v[24:27]
  v_and_b32_dpp v16, v33, v4 row_newbcast:8 row_mask:0xf bank_mask:0xf
  v_and_b32_dpp v17, v33, v5 row_newbcast:8 row_mask:0xf bank_mask:0xf
  v_and_b32_dpp v18, v33, v6 row_newbcast:8 row_mask:0xf bank_mask:0xf
  v_and_b32_dpp v19, v33, v7 row_newbcast:8 row_mask:0xf bank_mask:0xf
  v_mfma_f32_16x16x32_bf16 v[24:27], v[20:23], v[92:95], v[24:27]
  v_and_b32_dpp v20, v33, v4 row_newbcast:9 row_mask:0xf bank_mask:0xf
  v_and_b32_dpp v21, v33, v5 row_newbcast:9 row_mask:0xf bank_mask:0xf
  v_and_b32_dpp v22, v33, v6 row_newbcast:9 row_mask:0xf bank_mask:0xf
  v_and_b32_dpp v23, v33, v7 row_newbcast:9 row_mask:0xf bank_mask:0xf
  v_mfma_f32_16x16x32_bf16 v[24:27], v[16:19], v[96:99], v[24:27]
  v_and_b32_dpp v16, v33, v4 row_newbcast:10 row_mask:0xf bank_mask:0xf
  v_and_b32_dpp v17, v33, v5 row_newbcast:10 row_mask:0xf bank_mask:0xf
  v_and_b32_dpp v18, v33, v6 row_newbcast:10 row_mask:0xf bank_mask:0xf
  v_and_b32_dpp v19, v33, v7 row_newbcast:10 row_mask:0xf bank_mask:0xf
  v_mfma_f32_16x16x32_bf16 v[24:27], v[20:23], v[100:103], v[24:27]
  v_and_b32_dpp v20, v33, v4 row_newbcast:11 row_mask:0xf bank_mask:0xf
  v_and_b32_dpp v21, v33, v5 row_newbcast:11 row_mask:0xf bank_mask:0xf
  v_and_b32_dpp v22, v33, v6 row_newbcast:11 row_mask:0xf bank_mask:0xf
  v_and_b32_dpp v23, v33, v7 row_newbcast:11 row_mask:0xf bank_mask:0xf
  v_mfma_f32_16x16x32_bf16 v[24:27], v[16:19], v[104:107], v[24:27]
  v_and_b32_dpp v16, v33, v4 row_newbcast:12 row_mask:0xf bank_mask:0xf
  v_and_b32_dpp v17, v33, v5 row_newbcast:12 row_mask:0xf bank_mask:0xf
  v_and_b32_dpp v18, v33, v6 row_newbcast:12 row_mask:0xf bank_mask:0xf
  v_and_b32_dpp v19, v33, v7 row_newbcast:12 row_mask:0xf bank_mask:0xf
  v_mfma_f32_16x16x32_bf16 v[24:27], v[20:23], v[108:111], v[24:27]
  v_and_b32_dpp v20, v33, v4 row_newbcast:13 row_mask:0xf bank_mask:0xf
  v_and_b32_dpp v21, v33, v5 row_newbcast:13 row_mask:0xf bank_mask:0xf
  v_and_b32_dpp v22, v33, v6 row_newbcast:13 row_mask:0xf bank_mask:0xf
  v_and_b32_dpp v23, v33, v7 row_newbcast:13 row_mask:0xf bank_mask:0xf
  v_mfma_f32_16x16x32_bf16 v[24:27], v[16:19], v[112:115], v[24:27]
  v_and_b32_dpp v16, v33, v4 row_newbcast:14 row_mask:0xf bank_mask:0xf
  v_and_b32_dpp v17, v33, v5 row_newbcast:14 row_mask:0xf bank_mask:0xf
  v_and_b32_dpp v18, v33, v6 row_newbcast:14 row_mask:0xf bank_mask:0xf
  v_and_b32_dpp v19, v33, v7 row_newbcast:14 row_mask:0xf bank_mask:0xf
  v_mfma_f32_16x16x32_bf16 v[24:27], v[20:23], v[116:119], v[24:27]
  v_and_b32_dpp v20, v33, v4 row_newbcast:15 row_mask:0xf bank_mask:0xf
  v_and_b32_dpp v21, v33, v5 row_newbcast:15 row_mask:0xf bank_mask:0xf
  v_and_b32_dpp v22, v33, v6 row_newbcast:15 row_mask:0xf bank_mask:0xf
  v_and_b32_dpp v23, v33, v7 row_newbcast:15 row_mask:0xf bank_mask:0xf
  s_waitcnt vmcnt(17)
  v_mfma_f32_16x16x32_bf16 v[24:27], v[16:19], v[120:123], v[24:27]
  s_nop 0
  s_waitcnt vmcnt(16)
  v_mfma_f32_16x16x32_bf16 v[24:27], v[20:23], v[124:127], v[24:27]
  v_and_b32_dpp v16, v34, v4 row_newbcast:0 row_mask:0xf bank_mask:0xf
  v_and_b32_dpp v17, v34, v5 row_newbcast:0 row_mask:0xf bank_mask:0xf
  v_and_b32_dpp v18, v34, v6 row_newbcast:0 row_mask:0xf bank_mask:0xf
  v_and_b32_dpp v19, v34, v7 row_newbcast:0 row_mask:0xf bank_mask:0xf
  v_and_b32_dpp v20, v34, v4 row_newbcast:1 row_mask:0xf bank_mask:0xf
  v_and_b32_dpp v21, v34, v5 row_newbcast:1 row_mask:0xf bank_mask:0xf
  v_and_b32_dpp v22, v34, v6 row_newbcast:1 row_mask:0xf bank_mask:0xf
  v_and_b32_dpp v23, v34, v7 row_newbcast:1 row_mask:0xf bank_mask:0xf
  s_waitcnt vmcnt(15)
  v_mfma_f32_16x16x32_bf16 v[24:27], v[16:19], v[128:131], v[24:27]
  v_and_b32_dpp v16, v34, v4 row_newbcast:2 row_mask:0xf bank_mask:0xf
  v_and_b32_dpp v17, v34, v5 row_newbcast:2 row_mask:0xf bank_mask:0xf
  v_and_b32_dpp v18, v34, v6 row_newbcast:2 row_mask:0xf bank_mask:0xf
  v_and_b32_dpp v19, v34, v7 row_newbcast:2 row_mask:0xf bank_mask:0xf
  s_waitcnt vmcnt(14)
  v_mfma_f32_16x16x32_bf16 v[24:27], v[20:23], v[132:135], v[24:27]
  v_and_b32_dpp v20, v34, v4 row_newbcast:3 row_mask:0xf bank_mask:0xf
  v_and_b32_dpp v21, v34, v5 row_newbcast:3 row_mask:0xf bank_mask:0xf
  v_and_b32_dpp v22, v34, v6 row_newbcast:3 row_mask:0xf bank_mask:0xf
  v_and_b32_dpp v23, v34, v7 row_newbcast:3 row_mask:0xf bank_mask:0xf
  s_waitcnt vmcnt(13)
  v_mfma_f32_16x16x32_bf16 v[24:27], v[16:19], v[136:139], v[24:27]
  v_and_b32_dpp v16, v34, v4 row_newbcast:4 row_mask:0xf bank_mask:0xf
  v_and_b32_dpp v17, v34, v5 row_newbcast:4 row_mask:0xf bank_mask:0xf
  v_and_b32_dpp v18, v34, v6 row_newbcast:4 row_mask:0xf bank_mask:0xf
  v_and_b32_dpp v19, v34, v7 row_newbcast:4 row_mask:0xf bank_mask:0xf
  s_waitcnt vmcnt(12)
  v_mfma_f32_16x16x32_bf16 v[24:27], v[20:23], v[140:143], v[24:27]
  v_and_b32_dpp v20, v34, v4 row_newbcast:5 row_mask:0xf bank_mask:0xf
  v_and_b32_dpp v21, v34, v5 row_newbcast:5 row_mask:0xf bank_mask:0xf
  v_and_b32_dpp v22, v34, v6 row_newbcast:5 row_mask:0xf bank_mask:0xf
  v_and_b32_dpp v23, v34, v7 row_newbcast:5 row_mask:0xf bank_mask:0xf
  s_waitcnt vmcnt(11)
  v_mfma_f32_16x16x32_bf16 v[24:27], v[16:19], v[144:147], v[24:27]
  v_and_b32_dpp v16, v34, v4 row_newbcast:6 row_mask:0xf bank_mask:0xf
  v_and_b32_dpp v17, v34, v5 row_newbcast:6 row_mask:0xf bank_mask:0xf
  v_and_b32_dpp v18, v34, v6 row_newbcast:6 row_mask:0xf bank_mask:0xf
  v_and_b32_dpp v19, v34, v7 row_newbcast:6 row_mask:0xf bank_mask:0xf
  s_waitcnt vmcnt(10)
  v_mfma_f32_16x16x32_bf16 v[24:27], v[20:23], v[148:151], v[24:27]
  v_and_b32_dpp v20, v34, v4 row_newbcast:7 row_mask:0xf bank_mask:0xf
  v_and_b32_dpp v21, v34, v5 row_newbcast:7 row_mask:0xf bank_mask:0xf
  v_and_b32_dpp v22, v34, v6 row_newbcast:7 row_mask:0xf bank_mask:0xf
  v_and_b32_dpp v23, v34, v7 row_newbcast:7 row_mask:0xf bank_mask:0xf
  s_waitcnt vmcnt(9)
  v_mfma_f32_16x16x32_bf16 v[24:27], v[16:19], v[152:155], v[24:27]
  v_and_b32_dpp v16, v34, v4 row_newbcast:8 row_mask:0xf bank_mask:0xf
  v_and_b32_dpp v17, v34, v5 row_newbcast:8 row_mask:0xf bank_mask:0xf
  v_and_b32_dpp v18, v34, v6 row_newbcast:8 row_mask:0xf bank_mask:0xf
  v_and_b32_dpp v19, v34, v7 row_newbcast:8 row_mask:0xf bank_mask:0xf
  s_waitcnt vmcnt(8)
  v_mfma_f32_16x16x32_bf16 v[24:27], v[20:23], v[156:159], v[24:27]
  v_and_b32_dpp v20, v34, v4 row_newbcast:9 row_mask:0xf bank_mask:0xf
  v_and_b32_dpp v21, v34, v5 row_newbcast:9 row_mask:0xf bank_mask:0xf
  v_and_b32_dpp v22, v34, v6 row_newbcast:9 row_mask:0xf bank_mask:0xf
  v_and_b32_dpp v23, v34, v7 row_newbcast:9 row_mask:0xf bank_mask:0xf
  s_waitcnt vmcnt(7)
  v_mfma_f32_16x16x32_bf16 v[24:27], v[16:19], v[160:163], v[24:27]
  v_and_b32_dpp v16, v34, v4 row_newbcast:10 row_mask:0xf bank_mask:0xf
  v_and_b32_dpp v17, v34, v5 row_newbcast:10 row_mask:0xf bank_mask:0xf
  v_and_b32_dpp v18, v34, v6 row_newbcast:10 row_mask:0xf bank_mask:0xf
  v_and_b32_dpp v19, v34, v7 row_newbcast:10 row_mask:0xf bank_mask:0xf
  s_waitcnt vmcnt(6)
  v_mfma_f32_16x16x32_bf16 v[24:27], v[20:23], v[164:167], v[24:27]
  v_and_b32_dpp v20, v34, v4 row_newbcast:11 row_mask:0xf bank_mask:0xf
  v_and_b32_dpp v21, v34, v5 row_newbcast:11 row_mask:0xf bank_mask:0xf
  v_and_b32_dpp v22, v34, v6 row_newbcast:11 row_mask:0xf bank_mask:0xf
  v_and_b32_dpp v23, v34, v7 row_newbcast:11 row_mask:0xf bank_mask:0xf
  s_waitcnt vmcnt(5)
  v_mfma_f32_16x16x32_bf16 v[24:27], v[16:19], v[168:171], v[24:27]
  v_and_b32_dpp v16, v34, v4 row_newbcast:12 row_mask:0xf bank_mask:0xf
  v_and_b32_dpp v17, v34, v5 row_newbcast:12 row_mask:0xf bank_mask:0xf
  v_and_b32_dpp v18, v34, v6 row_newbcast:12 row_mask:0xf bank_mask:0xf
  v_and_b32_dpp v19, v34, v7 row_newbcast:12 row_mask:0xf bank_mask:0xf
  s_waitcnt vmcnt(4)
  v_mfma_f32_16x16x32_bf16 v[24:27], v[20:23], v[172:175], v[24:27]
  v_and_b32_dpp v20, v34, v4 row_newbcast:13 row_mask:0xf bank_mask:0xf
  v_and_b32_dpp v21, v34, v5 row_newbcast:13 row_mask:0xf bank_mask:0xf
  v_and_b32_dpp v22, v34, v6 row_newbcast:13 row_mask:0xf bank_mask:0xf
  v_and_b32_dpp v23, v34, v7 row_newbcast:13 row_mask:0xf bank_mask:0xf
  s_waitcnt vmcnt(3)
  v_mfma_f32_16x16x32_bf16 v[24:27], v[16:19], v[176:179], v[24:27]
  v_and_b32_dpp v16, v34, v4 row_newbcast:14 row_mask:0xf bank_mask:0xf
  v_and_b32_dpp v17, v34, v5 row_newbcast:14 row_mask:0xf bank_mask:0xf
  v_and_b32_dpp v18, v34, v6 row_newbcast:14 row_mask:0xf bank_mask:0xf
  v_and_b32_dpp v19, v34, v7 row_newbcast:14 row_mask:0xf bank_mask:0xf
  s_waitcnt vmcnt(2)
  v_mfma_f32_16x16x32_bf16 v[24:27], v[20:23], v[180:183], v[24:27]
  v_and_b32_dpp v20, v34, v4 row_newbcast:15 row_mask:0xf bank_mask:0xf
  v_and_b32_dpp v21, v34, v5 row_newbcast:15 row_mask:0xf bank_mask:0xf
  v_and_b32_dpp v22, v34, v6 row_newbcast:15 row_mask:0xf bank_mask:0xf
  v_and_b32_dpp v23, v34, v7 row_newbcast:15 row_mask:0xf bank_mask:0xf
  s_waitcnt vmcnt(1)
  v_mfma_f32_16x16x32_bf16 v[24:27], v[16:19], v[184:187], v[24:27]
  s_nop 0
  s_waitcnt vmcnt(0)
  v_mfma_f32_16x16x32_bf16 v[24:27], v[20:23], v[188:191], v[24:27]
  s_nop 6
  s_mov_b64 exec, s[64:65]
  ds_write_b128 v55, v[24:27] offset:4096
  s_mov_b64 exec, -1
  s_waitcnt lgkmcnt(0)
  s_barrier
  s_and_b32 s50, s3, 0x19
  s_cbranch_scc1 L_sdone
  s_lshl_b32 s50, s31, 16
  s_add_u32 s44, s28, s50
  s_addc_u32 s45, s29, 0
  s_mov_b32 s46, 0x10000
  s_mov_b32 s47, 0x20000
  s_lshr_b32 s52, s3, 1
  s_lshl_b32 s52, s52, 2
  s_add_u32 s52, s52, s30
  v_lshrrev_b32 v10, 3, v1
  v_lshlrev_b32 v10, 11, v10
  v_and_b32 v11, 7, v1
  v_lshl_add_u32 v10, v11, 4, v10
  s_lshl_b32 s50, s52, 7
  v_add_u32 v10, s50, v10
  s_lshl_b32 s50, s52, 6
  v_lshlrev_b32 v11, 3, v11
  v_add_u32 v11, s50, v11
  s_lshl_b32 s50, s31, 10
  v_add_u32 v12, s50, v11
  s_mov_b32 s49, 0
  s_movk_i32 s50, 0x4000
  s_mov_b32 s51, 0x8000
  s_mov_b32 s52, 0xc000
  s_mov_b64 s[58:59], -1
  s_mov_b64 s[60:61], -1
  s_mov_b64 s[62:63], -1
  s_mov_b64 s[64:65], -1
  s_waitcnt vmcnt(0)
  v_lshlrev_b32 v28, 16, v56
  v_lshlrev_b32 v73, 16, v58
  v_add_f32 v28, v28, v73
  v_and_b32 v29, 0xffff0000, v56
  v_and_b32 v73, 0xffff0000, v58
  v_add_f32 v29, v29, v73
  v_lshlrev_b32 v30, 16, v57
  v_lshlrev_b32 v73, 16, v59
  v_add_f32 v30, v30, v73
  v_and_b32 v31, 0xffff0000, v57
  v_and_b32 v73, 0xffff0000, v59
  v_add_f32 v31, v31, v73
L_poll:
  s_mov_b64 exec, s[58:59]
  s_cbranch_execz L_pk0
  buffer_load_dwordx4 v[64:67], v10, s[44:47], 0 offen sc1
L_pk0:
  s_mov_b64 exec, s[60:61]
  s_cbranch_execz L_pk1
  buffer_load_dwordx4 v[68:71], v10, s[44:47], s50 offen sc1
L_pk1:
  s_mov_b64 exec, s[62:63]
  s_cbranch_execz L_pk2
  buffer_load_dwordx4 v[72:75], v10, s[44:47], s51 offen sc1
L_pk2:
  s_mov_b64 exec, s[64:65]
  s_cbranch_execz L_pk3
  buffer_load_dwordx4 v[76:79], v10, s[44:47], s52 offen sc1
L_pk3:
  s_mov_b64 exec, -1
  s_add_u32 s49, s49, 1
  s_waitcnt vmcnt(0)
  v_max3_u32 v16, v64, v65, v66
  v_max_u32 v16, v16, v67
  v_max3_u32 v17, v68, v69, v70
  v_max_u32 v17, v17, v71
  v_max3_u32 v18, v72, v73, v74
  v_max_u32 v18, v18, v75
  v_max3_u32 v19, v76, v77, v78
  v_max_u32 v19, v19, v79
  v_cmp_eq_u32 s[58:59], -1, v16
  v_cmp_eq_u32 s[60:61], -1, v17
  v_cmp_eq_u32 s[62:63], -1, v18
  v_cmp_eq_u32 s[64:65], -1, v19
  s_cmp_gt_u32 s49, 0x80000
  s_cbranch_scc1 L_pdone
  s_or_b64 vcc, s[58:59], s[60:61]
  s_or_b64 vcc, vcc, s[62:63]
  s_or_b64 vcc, vcc, s[64:65]
  s_cbranch_scc0 L_pdone
  s_branch L_poll
L_pdone:
  v_add_f32 v64, v64, v68
  v_add_f32 v72, v72, v76
  v_add_f32 v65, v65, v69
  v_add_f32 v73, v73, v77
  v_add_f32 v66, v66, v70
  v_add_f32 v74, v74, v78
  v_add_f32 v67, v67, v71
  v_add_f32 v75, v75, v79
  v_add_f32 v64, v64, v72
  v_add_f32 v65, v65, v73
  v_add_f32 v66, v66, v74
  v_add_f32 v67, v67, v75
  s_nop 1
  v_add_f32_dpp v64, v64, v64 row_ror:8 row_mask:0xf bank_mask:0xf
  v_add_f32_dpp v65, v65, v65 row_ror:8 row_mask:0xf bank_mask:0xf
  v_add_f32_dpp v66, v66, v66 row_ror:8 row_mask:0xf bank_mask:0xf
  v_add_f32_dpp v67, v67, v67 row_ror:8 row_mask:0xf bank_mask:0xf
  v_mov_b32 v68, v64
  v_mov_b32 v69, v65
  v_mov_b32 v70, v66
  v_mov_b32 v71, v67
  s_nop 1
  v_permlane16_swap_b32 v64, v68
  v_permlane16_swap_b32 v65, v69
  v_permlane16_swap_b32 v66, v70
  v_permlane16_swap_b32 v67, v71
  s_nop 1
  v_add_f32 v64, v64, v68
  v_add_f32 v65, v65, v69
  v_add_f32 v66, v66, v70
  v_add_f32 v67, v67, v71
  v_mov_b32 v68, v64
  v_mov_b32 v69, v65
  v_mov_b32 v70, v66
  v_mov_b32 v71, v67
  s_nop 1
  v_permlane32_swap_b32 v64, v68
  v_permlane32_swap_b32 v65, v69
  v_permlane32_swap_b32 v66, v70
  v_permlane32_swap_b32 v67, v71
  s_nop 1
  v_add_f32 v64, v64, v68
  v_add_f32 v65, v65, v69
  v_add_f32 v66, v66, v70
  v_add_f32 v67, v67, v71
  v_add_f32 v64, v64, v28
  v_add_f32 v65, v65, v29
  v_add_f32 v66, v66, v30
  v_add_f32 v67, v67, v31
  v_cvt_pk_bf16_f32 v74, v64, v65
  v_cvt_pk_bf16_f32 v75, v66, v67
  s_mov_b64 exec, 0xff
  global_store_dwordx2 v12, v[74:75], s[24:25]
  s_mov_b64 exec, -1
L_sdone:
  s_endpgm
L_helper:
  s_setprio 0
  s_sub_u32 s57, s30, 4
  s_lshl_b32 s50, s31, 10
  v_lshlrev_b32 v10, 4, v1
  v_add_u32 v10, s50, v10
  s_lshl_b32 s51, s57, 8
  s_add_u32 s50, s50, s51
  v_lshlrev_b32 v11, 2, v1
  v_add_u32 v11, s50, v11
  s_lshl_b32 s50, s57, 20
  s_lshl_b32 s51, s3, 8
  s_add_u32 s50, s50, s51
  v_lshlrev_b32 v8, 18, v2
  v_lshl_add_u32 v8, v3, 4, v8
  v_add_u32 v8, s50, v8
  s_and_b32 s55, s3, 7
  s_lshl_b32 s55, s55, 2
  s_lshr_b32 s50, s3, 3
  s_or_b32 s55, s55, s50
  s_mul_i32 s55, s55, 43
  s_add_u32 s50, s55, 43
  s_lshr_b32 s55, s55, 3
  s_lshr_b32 s50, s50, 3
  s_sub_u32 s56, s50, s55
  s_mov_b32 s48, 0
  s_waitcnt lgkmcnt(0)
  global_load_dwordx4 v[56:59], v10, s[4:5]
  global_load_dword v38, v11, s[4:5]
  s_mov_b32 s32, s10
  s_mov_b32 s33, s11
  s_mov_b32 s34, 4194304
  s_mov_b32 s35, 0x20000
  buffer_load_dwordx4 v[128:131], v8, s[32:35], s48 offen
  s_add_u32 s48, s48, 8192
  buffer_load_dwordx4 v[132:135], v8, s[32:35], s48 offen
  s_add_u32 s48, s48, 8192
  buffer_load_dwordx4 v[136:139], v8, s[32:35], s48 offen
  s_add_u32 s48, s48, 8192
  buffer_load_dwordx4 v[140:143], v8, s[32:35], s48 offen
  s_add_u32 s48, s48, 8192
  buffer_load_dwordx4 v[144:147], v8, s[32:35], s48 offen
  s_add_u32 s48, s48, 8192
  buffer_load_dwordx4 v[148:151], v8, s[32:35], s48 offen
  s_add_u32 s48, s48, 8192
  buffer_load_dwordx4 v[152:155], v8, s[32:35], s48 offen
  s_add_u32 s48, s48, 8192
  buffer_load_dwordx4 v[156:159], v8, s[32:35], s48 offen
  s_add_u32 s48, s48, 8192
  buffer_load_dwordx4 v[160:163], v8, s[32:35], s48 offen
  s_add_u32 s48, s48, 8192
  buffer_load_dwordx4 v[164:167], v8, s[32:35], s48 offen
  s_add_u32 s48, s48, 8192
  buffer_load_dwordx4 v[168:171], v8, s[32:35], s48 offen
  s_add_u32 s48, s48, 8192
  buffer_load_dwordx4 v[172:175], v8, s[32:35], s48 offen
  s_add_u32 s48, s48, 8192
  buffer_load_dwordx4 v[176:179], v8, s[32:35], s48 offen
  s_add_u32 s48, s48, 8192
  buffer_load_dwordx4 v[180:183], v8, s[32:35], s48 offen
  s_add_u32 s48, s48, 8192
  buffer_load_dwordx4 v[184:187], v8, s[32:35], s48 offen
  s_add_u32 s48, s48, 8192
  buffer_load_dwordx4 v[188:191], v8, s[32:35], s48 offen
  s_add_u32 s48, s48, 8192
  buffer_load_dwordx4 v[192:195], v8, s[32:35], s48 offen
  s_add_u32 s48, s48, 8192
  buffer_load_dwordx4 v[196:199], v8, s[32:35], s48 offen
  s_add_u32 s48, s48, 8192
  buffer_load_dwordx4 v[200:203], v8, s[32:35], s48 offen
  s_add_u32 s48, s48, 8192
  buffer_load_dwordx4 v[204:207], v8, s[32:35], s48 offen
  s_add_u32 s48, s48, 8192
  buffer_load_dwordx4 v[208:211], v8, s[32:35], s48 offen
  s_add_u32 s48, s48, 8192
  buffer_load_dwordx4 v[212:215], v8, s[32:35], s48 offen
  s_add_u32 s48, s48, 8192
  buffer_load_dwordx4 v[216:219], v8, s[32:35], s48 offen
  s_add_u32 s48, s48, 8192
  buffer_load_dwordx4 v[220:223], v8, s[32:35], s48 offen
  s_add_u32 s48, s48, 8192
  buffer_load_dwordx4 v[224:227], v8, s[32:35], s48 offen
  s_add_u32 s48, s48, 8192
  buffer_load_dwordx4 v[228:231], v8, s[32:35], s48 offen
  s_add_u32 s48, s48, 8192
  buffer_load_dwordx4 v[232:235], v8, s[32:35], s48 offen
  s_add_u32 s48, s48, 8192
  buffer_load_dwordx4 v[236:239], v8, s[32:35], s48 offen
  s_add_u32 s48, s48, 8192
  buffer_load_dwordx4 v[240:243], v8, s[32:35], s48 offen
  s_add_u32 s48, s48, 8192
  buffer_load_dwordx4 v[244:247], v8, s[32:35], s48 offen
  s_add_u32 s48, s48, 8192
  buffer_load_dwordx4 v[248:251], v8, s[32:35], s48 offen
  s_add_u32 s48, s48, 8192
  buffer_load_dwordx4 v[252:255], v8, s[32:35], s48 offen
  s_add_u32 s48, s48, 8192
  v_and_b32 v10, 1, v3
  v_lshlrev_b32 v10, 4, v10
  v_mov_b32 v11, 0xffff
  v_lshlrev_b32 v11, v10, v11
  v_lshrrev_b32 v12, 1, v3
  v_cmp_eq_u32 vcc, 0, v12
  s_nop 1
  v_cndmask_b32 v4, 0, v11, vcc
  v_cmp_eq_u32 vcc, 1, v12
  s_nop 1
  v_cndmask_b32 v5, 0, v11, vcc
  v_cmp_eq_u32 vcc, 2, v12
  s_nop 1
  v_cndmask_b32 v6, 0, v11, vcc
  v_cmp_eq_u32 vcc, 3, v12
  s_nop 1
  v_cndmask_b32 v7, 0, v11, vcc
  v_and_b32 v10, 1, v3
  v_lshlrev_b32 v10, 4, v10
  v_mov_b32 v11, 0xffff
  v_lshlrev_b32 v11, v10, v11
  v_bfe_u32 v12, v3, 1, 2
  v_cmp_eq_u32 vcc, 0, v12
  s_nop 1
  v_cndmask_b32 v32, 0, v11, vcc
  v_cmp_eq_u32 vcc, 1, v12
  s_nop 1
  v_cndmask_b32 v33, 0, v11, vcc
  v_cmp_eq_u32 vcc, 2, v12
  s_nop 1
  v_cndmask_b32 v34, 0, v11, vcc
  v_cmp_eq_u32 vcc, 3, v12
  s_nop 1
  v_cndmask_b32 v35, 0, v11, vcc
  s_waitcnt vmcnt(32)
  v_lshlrev_b32 v48, 16, v56
  v_and_b32 v49, 0xffff0000, v56
  v_lshlrev_b32 v50, 16, v57
  v_and_b32 v51, 0xffff0000, v57
  v_lshlrev_b32 v52, 16, v58
  v_and_b32 v53, 0xffff0000, v58
  v_lshlrev_b32 v54, 16, v59
  v_and_b32 v55, 0xffff0000, v59
  v_add_f32 v10, v48, v49
  v_add_f32 v11, v50, v51
  v_add_f32 v12, v52, v53
  v_add_f32 v13, v54, v55
  v_add_f32 v10, v10, v11
  v_add_f32 v12, v12, v13
  v_add_f32 v10, v10, v12
  s_nop 1
  v_add_f32_dpp v10, v10, v10 row_ror:8 row_mask:0xf bank_mask:0xf
  s_nop 1
  v_add_f32_dpp v10, v10, v10 row_ror:4 row_mask:0xf bank_mask:0xf
  s_nop 1
  v_add_f32_dpp v10, v10, v10 row_ror:2 row_mask:0xf bank_mask:0xf
  s_nop 1
  v_add_f32_dpp v10, v10, v10 row_ror:1 row_mask:0xf bank_mask:0xf
  s_nop 1
  v_add_f32_dpp v10, v10, v10 row_bcast:15 row_mask:0xa bank_mask:0xf
  s_nop 1
  v_add_f32_dpp v10, v10, v10 row_bcast:31 row_mask:0xc bank_mask:0xf
  s_nop 1
  v_readlane_b32 s50, v10, 63
  s_nop 1
  v_mov_b32 v10, 0x3b000000
  v_mul_f32 v10, s50, v10
  v_sub_f32 v48, v48, v10
  v_sub_f32 v49, v49, v10
  v_sub_f32 v50, v50, v10
  v_sub_f32 v51, v51, v10
  v_sub_f32 v52, v52, v10
  v_sub_f32 v53, v53, v10
  v_sub_f32 v54, v54, v10
  v_sub_f32 v55, v55, v10
  v_mul_f32 v11, v48, v48
  v_fmac_f32 v11, v49, v49
  v_fmac_f32 v11, v50, v50
  v_fmac_f32 v11, v51, v51
  v_fmac_f32 v11, v52, v52
  v_fmac_f32 v11, v53, v53
  v_fmac_f32 v11, v54, v54
  v_fmac_f32 v11, v55, v55
  s_nop 1
  v_add_f32_dpp v11, v11, v11 row_ror:8 row_mask:0xf bank_mask:0xf
  s_nop 1
  v_add_f32_dpp v11, v11, v11 row_ror:4 row_mask:0xf bank_mask:0xf
  s_nop 1
  v_add_f32_dpp v11, v11, v11 row_ror:2 row_mask:0xf bank_mask:0xf
  s_nop 1
  v_add_f32_dpp v11, v11, v11 row_ror:1 row_mask:0xf bank_mask:0xf
  s_nop 1
  v_add_f32_dpp v11, v11, v11 row_bcast:15 row_mask:0xa bank_mask:0xf
  s_nop 1
  v_add_f32_dpp v11, v11, v11 row_bcast:31 row_mask:0xc bank_mask:0xf
  s_nop 1
  v_readlane_b32 s51, v11, 63
  s_nop 1
  v_mov_b32 v11, 0x3b000000
  v_mul_f32 v11, s51, v11
  v_cvt_pk_bf16_f32 v40, v10, v10
  v_lshlrev_b32 v40, 16, v40
  v_cvt_pk_bf16_f32 v11, v11, v11
  v_lshlrev_b32 v11, 16, v11
  v_add_f32 v11, 0x3727c5ac, v11
  v_cvt_pk_bf16_f32 v11, v11, v11
  v_lshlrev_b32 v11, 16, v11
  v_sqrt_f32 v11, v11
  s_nop 0
  v_cvt_pk_bf16_f32 v11, v11, v11
  v_lshlrev_b32 v41, 16, v11
  v_rcp_f32 v42, v41
  v_lshlrev_b32 v14, 16, v38
  v_and_b32 v15, 0xffff0000, v38
  v_sub_f32 v14, v14, v40
  v_cvt_pk_bf16_f32 v14, v14, v14
  v_lshlrev_b32 v14, 16, v14
  v_mul_f32 v12, v14, v42
  v_fma_f32 v13, -v12, v41, v14
  v_fmac_f32 v12, v13, v42
  v_cvt_pk_bf16_f32 v36, v12, v12
  v_sub_f32 v15, v15, v40
  v_cvt_pk_bf16_f32 v15, v15, v15
  v_lshlrev_b32 v15, 16, v15
  v_mul_f32 v12, v15, v42
  v_fma_f32 v13, -v12, v41, v15
  v_fmac_f32 v12, v13, v42
  v_cvt_pk_bf16_f32 v37, v12, v12
  v_mov_b32 v24, 0
  v_mov_b32 v25, 0
  v_mov_b32 v26, 0
  v_mov_b32 v27, 0
  v_mov_b32 v28, 0
  v_mov_b32 v29, 0
  v_mov_b32 v30, 0
  v_mov_b32 v31, 0
  v_and_b32_dpp v16, v36, v4 row_newbcast:0 row_mask:0xf bank_mask:0xf
  v_and_b32_dpp v17, v36, v5 row_newbcast:0 row_mask:0xf bank_mask:0xf
  v_and_b32_dpp v18, v36, v6 row_newbcast:0 row_mask:0xf bank_mask:0xf
  v_and_b32_dpp v19, v36, v7 row_newbcast:0 row_mask:0xf bank_mask:0xf
  v_and_b32_dpp v20, v37, v4 row_newbcast:0 row_mask:0xf bank_mask:0xf
  v_and_b32_dpp v21, v37, v5 row_newbcast:0 row_mask:0xf bank_mask:0xf
  v_and_b32_dpp v22, v37, v6 row_newbcast:0 row_mask:0xf bank_mask:0xf
  v_and_b32_dpp v23, v37, v7 row_newbcast:0 row_mask:0xf bank_mask:0xf
  s_waitcnt vmcnt(31)
  v_mfma_f32_16x16x32_bf16 v[24:27], v[16:19], v[128:131], v[24:27]
  v_and_b32_dpp v16, v36, v4 row_newbcast:1 row_mask:0xf bank_mask:0xf
  v_and_b32_dpp v17, v36, v5 row_newbcast:1 row_mask:0xf bank_mask:0xf
  v_and_b32_dpp v18, v36, v6 row_newbcast:1 row_mask:0xf bank_mask:0xf
  v_and_b32_dpp v19, v36, v7 row_newbcast:1 row_mask:0xf bank_mask:0xf
  s_waitcnt vmcnt(30)
  v_mfma_f32_16x16x32_bf16 v[24:27], v[20:23], v[132:135], v[24:27]
  v_and_b32_dpp v20, v37, v4 row_newbcast:1 row_mask:0xf bank_mask:0xf
  v_and_b32_dpp v21, v37, v5 row_newbcast:1 row_mask:0xf bank_mask:0xf
  v_and_b32_dpp v22, v37, v6 row_newbcast:1 row_mask:0xf bank_mask:0xf
  v_and_b32_dpp v23, v37, v7 row_newbcast:1 row_mask:0xf bank_mask:0xf
  s_waitcnt vmcnt(29)
  v_mfma_f32_16x16x32_bf16 v[24:27], v[16:19], v[136:139], v[24:27]
  v_and_b32_dpp v16, v36, v4 row_newbcast:2 row_mask:0xf bank_mask:0xf
  v_and_b32_dpp v17, v36, v5 row_newbcast:2 row_mask:0xf bank_mask:0xf
  v_and_b32_dpp v18, v36, v6 row_newbcast:2 row_mask:0xf bank_mask:0xf
  v_and_b32_dpp v19, v36, v7 row_newbcast:2 row_mask:0xf bank_mask:0xf
  s_waitcnt vmcnt(28)
  v_mfma_f32_16x16x32_bf16 v[24:27], v[20:23], v[140:143], v[24:27]
  v_and_b32_dpp v20, v37, v4 row_newbcast:2 row_mask:0xf bank_mask:0xf
  v_and_b32_dpp v21, v37, v5 row_newbcast:2 row_mask:0xf bank_mask:0xf
  v_and_b32_dpp v22, v37, v6 row_newbcast:2 row_mask:0xf bank_mask:0xf
  v_and_b32_dpp v23, v37, v7 row_newbcast:2 row_mask:0xf bank_mask:0xf
  s_waitcnt vmcnt(27)
  v_mfma_f32_16x16x32_bf16 v[24:27], v[16:19], v[144:147], v[24:27]
  v_and_b32_dpp v16, v36, v4 row_newbcast:3 row_mask:0xf bank_mask:0xf
  v_and_b32_dpp v17, v36, v5 row_newbcast:3 row_mask:0xf bank_mask:0xf
  v_and_b32_dpp v18, v36, v6 row_newbcast:3 row_mask:0xf bank_mask:0xf
  v_and_b32_dpp v19, v36, v7 row_newbcast:3 row_mask:0xf bank_mask:0xf
  s_waitcnt vmcnt(26)
  v_mfma_f32_16x16x32_bf16 v[24:27], v[20:23], v[148:151], v[24:27]
  v_and_b32_dpp v20, v37, v4 row_newbcast:3 row_mask:0xf bank_mask:0xf
  v_and_b32_dpp v21, v37, v5 row_newbcast:3 row_mask:0xf bank_mask:0xf
  v_and_b32_dpp v22, v37, v6 row_newbcast:3 row_mask:0xf bank_mask:0xf
  v_and_b32_dpp v23, v37, v7 row_newbcast:3 row_mask:0xf bank_mask:0xf
  s_waitcnt vmcnt(25)
  v_mfma_f32_16x16x32_bf16 v[24:27], v[16:19], v[152:155], v[24:27]
  v_and_b32_dpp v16, v36, v4 row_newbcast:4 row_mask:0xf bank_mask:0xf
  v_and_b32_dpp v17, v36, v5 row_newbcast:4 row_mask:0xf bank_mask:0xf
  v_and_b32_dpp v18, v36, v6 row_newbcast:4 row_mask:0xf bank_mask:0xf
  v_and_b32_dpp v19, v36, v7 row_newbcast:4 row_mask:0xf bank_mask:0xf
  s_waitcnt vmcnt(24)
  v_mfma_f32_16x16x32_bf16 v[24:27], v[20:23], v[156:159], v[24:27]
  v_and_b32_dpp v20, v37, v4 row_newbcast:4 row_mask:0xf bank_mask:0xf
  v_and_b32_dpp v21, v37, v5 row_newbcast:4 row_mask:0xf bank_mask:0xf
  v_and_b32_dpp v22, v37, v6 row_newbcast:4 row_mask:0xf bank_mask:0xf
  v_and_b32_dpp v23, v37, v7 row_newbcast:4 row_mask:0xf bank_mask:0xf
  s_waitcnt vmcnt(23)
  v_mfma_f32_16x16x32_bf16 v[24:27], v[16:19], v[160:163], v[24:27]
  v_and_b32_dpp v16, v36, v4 row_newbcast:5 row_mask:0xf bank_mask:0xf
  v_and_b32_dpp v17, v36, v5 row_newbcast:5 row_mask:0xf bank_mask:0xf
  v_and_b32_dpp v18, v36, v6 row_newbcast:5 row_mask:0xf bank_mask:0xf
  v_and_b32_dpp v19, v36, v7 row_newbcast:5 row_mask:0xf bank_mask:0xf
  s_waitcnt vmcnt(22)
  v_mfma_f32_16x16x32_bf16 v[24:27], v[20:23], v[164:167], v[24:27]
  v_and_b32_dpp v20, v37, v4 row_newbcast:5 row_mask:0xf bank_mask:0xf
  v_and_b32_dpp v21, v37, v5 row_newbcast:5 row_mask:0xf bank_mask:0xf
  v_and_b32_dpp v22, v37, v6 row_newbcast:5 row_mask:0xf bank_mask:0xf
  v_and_b32_dpp v23, v37, v7 row_newbcast:5 row_mask:0xf bank_mask:0xf
  s_waitcnt vmcnt(21)
  v_mfma_f32_16x16x32_bf16 v[24:27], v[16:19], v[168:171], v[24:27]
  v_and_b32_dpp v16, v36, v4 row_newbcast:6 row_mask:0xf bank_mask:0xf
  v_and_b32_dpp v17, v36, v5 row_newbcast:6 row_mask:0xf bank_mask:0xf
  v_and_b32_dpp v18, v36, v6 row_newbcast:6 row_mask:0xf bank_mask:0xf
  v_and_b32_dpp v19, v36, v7 row_newbcast:6 row_mask:0xf bank_mask:0xf
  s_waitcnt vmcnt(20)
  v_mfma_f32_16x16x32_bf16 v[24:27], v[20:23], v[172:175], v[24:27]
  v_and_b32_dpp v20, v37, v4 row_newbcast:6 row_mask:0xf bank_mask:0xf
  v_and_b32_dpp v21, v37, v5 row_newbcast:6 row_mask:0xf bank_mask:0xf
  v_and_b32_dpp v22, v37, v6 row_newbcast:6 row_mask:0xf bank_mask:0xf
  v_and_b32_dpp v23, v37, v7 row_newbcast:6 row_mask:0xf bank_mask:0xf
  s_waitcnt vmcnt(19)
  v_mfma_f32_16x16x32_bf16 v[24:27], v[16:19], v[176:179], v[24:27]
  v_and_b32_dpp v16, v36, v4 row_newbcast:7 row_mask:0xf bank_mask:0xf
  v_and_b32_dpp v17, v36, v5 row_newbcast:7 row_mask:0xf bank_mask:0xf
  v_and_b32_dpp v18, v36, v6 row_newbcast:7 row_mask:0xf bank_mask:0xf
  v_and_b32_dpp v19, v36, v7 row_newbcast:7 row_mask:0xf bank_mask:0xf
  s_waitcnt vmcnt(18)
  v_mfma_f32_16x16x32_bf16 v[24:27], v[20:23], v[180:183], v[24:27]
  v_and_b32_dpp v20, v37, v4 row_newbcast:7 row_mask:0xf bank_mask:0xf
  v_and_b32_dpp v21, v37, v5 row_newbcast:7 row_mask:0xf bank_mask:0xf
  v_and_b32_dpp v22, v37, v6 row_newbcast:7 row_mask:0xf bank_mask:0xf
  v_and_b32_dpp v23, v37, v7 row_newbcast:7 row_mask:0xf bank_mask:0xf
  s_waitcnt vmcnt(17)
  v_mfma_f32_16x16x32_bf16 v[24:27], v[16:19], v[184:187], v[24:27]
  v_and_b32_dpp v16, v36, v4 row_newbcast:8 row_mask:0xf bank_mask:0xf
  v_and_b32_dpp v17, v36, v5 row_newbcast:8 row_mask:0xf bank_mask:0xf
  v_and_b32_dpp v18, v36, v6 row_newbcast:8 row_mask:0xf bank_mask:0xf
  v_and_b32_dpp v19, v36, v7 row_newbcast:8 row_mask:0xf bank_mask:0xf
  s_waitcnt vmcnt(16)
  v_mfma_f32_16x16x32_bf16 v[24:27], v[20:23], v[188:191], v[24:27]
  v_and_b32_dpp v20, v37, v4 row_newbcast:8 row_mask:0xf bank_mask:0xf
  v_and_b32_dpp v21, v37, v5 row_newbcast:8 row_mask:0xf bank_mask:0xf
  v_and_b32_dpp v22, v37, v6 row_newbcast:8 row_mask:0xf bank_mask:0xf
  v_and_b32_dpp v23, v37, v7 row_newbcast:8 row_mask:0xf bank_mask:0xf
  s_waitcnt vmcnt(15)
  v_mfma_f32_16x16x32_bf16 v[24:27], v[16:19], v[192:195], v[24:27]
  v_and_b32_dpp v16, v36, v4 row_newbcast:9 row_mask:0xf bank_mask:0xf
  v_and_b32_dpp v17, v36, v5 row_newbcast:9 row_mask:0xf bank_mask:0xf
  v_and_b32_dpp v18, v36, v6 row_newbcast:9 row_mask:0xf bank_mask:0xf
  v_and_b32_dpp v19, v36, v7 row_newbcast:9 row_mask:0xf bank_mask:0xf
  s_waitcnt vmcnt(14)
  v_mfma_f32_16x16x32_bf16 v[24:27], v[20:23], v[196:199], v[24:27]
  v_and_b32_dpp v20, v37, v4 row_newbcast:9 row_mask:0xf bank_mask:0xf
  v_and_b32_dpp v21, v37, v5 row_newbcast:9 row_mask:0xf bank_mask:0xf
  v_and_b32_dpp v22, v37, v6 row_newbcast:9 row_mask:0xf bank_mask:0xf
  v_and_b32_dpp v23, v37, v7 row_newbcast:9 row_mask:0xf bank_mask:0xf
  s_waitcnt vmcnt(13)
  v_mfma_f32_16x16x32_bf16 v[24:27], v[16:19], v[200:203], v[24:27]
  v_and_b32_dpp v16, v36, v4 row_newbcast:10 row_mask:0xf bank_mask:0xf
  v_and_b32_dpp v17, v36, v5 row_newbcast:10 row_mask:0xf bank_mask:0xf
  v_and_b32_dpp v18, v36, v6 row_newbcast:10 row_mask:0xf bank_mask:0xf
  v_and_b32_dpp v19, v36, v7 row_newbcast:10 row_mask:0xf bank_mask:0xf
  s_waitcnt vmcnt(12)
  v_mfma_f32_16x16x32_bf16 v[24:27], v[20:23], v[204:207], v[24:27]
  v_and_b32_dpp v20, v37, v4 row_newbcast:10 row_mask:0xf bank_mask:0xf
  v_and_b32_dpp v21, v37, v5 row_newbcast:10 row_mask:0xf bank_mask:0xf
  v_and_b32_dpp v22, v37, v6 row_newbcast:10 row_mask:0xf bank_mask:0xf
  v_and_b32_dpp v23, v37, v7 row_newbcast:10 row_mask:0xf bank_mask:0xf
  s_waitcnt vmcnt(11)
  v_mfma_f32_16x16x32_bf16 v[24:27], v[16:19], v[208:211], v[24:27]
  v_and_b32_dpp v16, v36, v4 row_newbcast:11 row_mask:0xf bank_mask:0xf
  v_and_b32_dpp v17, v36, v5 row_newbcast:11 row_mask:0xf bank_mask:0xf
  v_and_b32_dpp v18, v36, v6 row_newbcast:11 row_mask:0xf bank_mask:0xf
  v_and_b32_dpp v19, v36, v7 row_newbcast:11 row_mask:0xf bank_mask:0xf
  s_waitcnt vmcnt(10)
  v_mfma_f32_16x16x32_bf16 v[24:27], v[20:23], v[212:215], v[24:27]
  v_and_b32_dpp v20, v37, v4 row_newbcast:11 row_mask:0xf bank_mask:0xf
  v_and_b32_dpp v21, v37, v5 row_newbcast:11 row_mask:0xf bank_mask:0xf
  v_and_b32_dpp v22, v37, v6 row_newbcast:11 row_mask:0xf bank_mask:0xf
  v_and_b32_dpp v23, v37, v7 row_newbcast:11 row_mask:0xf bank_mask:0xf
  s_waitcnt vmcnt(9)
  v_mfma_f32_16x16x32_bf16 v[24:27], v[16:19], v[216:219], v[24:27]
  v_and_b32_dpp v16, v36, v4 row_newbcast:12 row_mask:0xf bank_mask:0xf
  v_and_b32_dpp v17, v36, v5 row_newbcast:12 row_mask:0xf bank_mask:0xf
  v_and_b32_dpp v18, v36, v6 row_newbcast:12 row_mask:0xf bank_mask:0xf
  v_and_b32_dpp v19, v36, v7 row_newbcast:12 row_mask:0xf bank_mask:0xf
  s_waitcnt vmcnt(8)
  v_mfma_f32_16x16x32_bf16 v[24:27], v[20:23], v[220:223], v[24:27]
  v_and_b32_dpp v20, v37, v4 row_newbcast:12 row_mask:0xf bank_mask:0xf
  v_and_b32_dpp v21, v37, v5 row_newbcast:12 row_mask:0xf bank_mask:0xf
  v_and_b32_dpp v22, v37, v6 row_newbcast:12 row_mask:0xf bank_mask:0xf
  v_and_b32_dpp v23, v37, v7 row_newbcast:12 row_mask:0xf bank_mask:0xf
  s_waitcnt vmcnt(7)
  v_mfma_f32_16x16x32_bf16 v[24:27], v[16:19], v[224:227], v[24:27]
  v_and_b32_dpp v16, v36, v4 row_newbcast:13 row_mask:0xf bank_mask:0xf
  v_and_b32_dpp v17, v36, v5 row_newbcast:13 row_mask:0xf bank_mask:0xf
  v_and_b32_dpp v18, v36, v6 row_newbcast:13 row_mask:0xf bank_mask:0xf
  v_and_b32_dpp v19, v36, v7 row_newbcast:13 row_mask:0xf bank_mask:0xf
  s_waitcnt vmcnt(6)
  v_mfma_f32_16x16x32_bf16 v[24:27], v[20:23], v[228:231], v[24:27]
  v_and_b32_dpp v20, v37, v4 row_newbcast:13 row_mask:0xf bank_mask:0xf
  v_and_b32_dpp v21, v37, v5 row_newbcast:13 row_mask:0xf bank_mask:0xf
  v_and_b32_dpp v22, v37, v6 row_newbcast:13 row_mask:0xf bank_mask:0xf
  v_and_b32_dpp v23, v37, v7 row_newbcast:13 row_mask:0xf bank_mask:0xf
  s_waitcnt vmcnt(5)
  v_mfma_f32_16x16x32_bf16 v[24:27], v[16:19], v[232:235], v[24:27]
  v_and_b32_dpp v16, v36, v4 row_newbcast:14 row_mask:0xf bank_mask:0xf
  v_and_b32_dpp v17, v36, v5 row_newbcast:14 row_mask:0xf bank_mask:0xf
  v_and_b32_dpp v18, v36, v6 row_newbcast:14 row_mask:0xf bank_mask:0xf
  v_and_b32_dpp v19, v36, v7 row_newbcast:14 row_mask:0xf bank_mask:0xf
  s_waitcnt vmcnt(4)
  v_mfma_f32_16x16x32_bf16 v[24:27], v[20:23], v[236:239], v[24:27]
  v_and_b32_dpp v20, v37, v4 row_newbcast:14 row_mask:0xf bank_mask:0xf
  v_and_b32_dpp v21, v37, v5 row_newbcast:14 row_mask:0xf bank_mask:0xf
  v_and_b32_dpp v22, v37, v6 row_newbcast:14 row_mask:0xf bank_mask:0xf
  v_and_b32_dpp v23, v37, v7 row_newbcast:14 row_mask:0xf bank_mask:0xf
  s_waitcnt vmcnt(3)
  v_mfma_f32_16x16x32_bf16 v[24:27], v[16:19], v[240:243], v[24:27]
  v_and_b32_dpp v16, v36, v4 row_newbcast:15 row_mask:0xf bank_mask:0xf
  v_and_b32_dpp v17, v36, v5 row_newbcast:15 row_mask:0xf bank_mask:0xf
  v_and_b32_dpp v18, v36, v6 row_newbcast:15 row_mask:0xf bank_mask:0xf
  v_and_b32_dpp v19, v36, v7 row_newbcast:15 row_mask:0xf bank_mask:0xf
  s_waitcnt vmcnt(2)
  v_mfma_f32_16x16x32_bf16 v[24:27], v[20:23], v[244:247], v[24:27]
  v_and_b32_dpp v20, v37, v4 row_newbcast:15 row_mask:0xf bank_mask:0xf
  v_and_b32_dpp v21, v37, v5 row_newbcast:15 row_mask:0xf bank_mask:0xf
  v_and_b32_dpp v22, v37, v6 row_newbcast:15 row_mask:0xf bank_mask:0xf
  v_and_b32_dpp v23, v37, v7 row_newbcast:15 row_mask:0xf bank_mask:0xf
  s_waitcnt vmcnt(1)
  v_mfma_f32_16x16x32_bf16 v[24:27], v[16:19], v[248:251], v[24:27]
  s_waitcnt vmcnt(0)
  v_mfma_f32_16x16x32_bf16 v[24:27], v[20:23], v[252:255], v[24:27]
  v_lshlrev_b32 v43, 5, v3
  v_lshl_add_u32 v43, v2, 4, v43
  s_lshl_b32 s50, s57, 9
  v_add_u32 v10, s50, v43
  v_mov_b32 v11, 0
  v_mov_b32 v12, 6400
  s_nop 2
  s_mov_b64 exec, s[64:65]
  ds_write_b128 v10, v[24:27] offset:0
  s_mov_b64 exec, -1
  ds_write_b32 v12, v11
  ds_write_b32 v12, v11 offset:4
  s_waitcnt lgkmcnt(0)
  s_barrier
  s_setprio 0
  v_lshrrev_b32 v10, 3, v3
  v_lshl_add_u32 v10, v2, 5, v10
  s_lshl_b32 s50, s57, 7
  v_add_u32 v10, s50, v10
  v_mul_u32_u24 v10, 2752, v10
  v_and_b32 v11, 7, v3
  v_add_u32 v12, s55, v11
  v_lshl_add_u32 v9, v12, 4, v10
  v_cmp_gt_u32 vcc, s56, v11
  v_mov_b32 v13, 0x40000000
  s_mov_b32 s48, 0
  v_cndmask_b32 v9, v13, v9, vcc
  s_mov_b32 s36, s16
  s_mov_b32 s37, s17
  s_mov_b32 s38, 1409024
  s_mov_b32 s39, 0x20000
  s_waitcnt vmcnt(1)
  buffer_load_dwordx4 v[64:67], v9, s[36:39], s48 offen
  s_add_u32 s48, s48, 5504
  s_waitcnt vmcnt(1)
  buffer_load_dwordx4 v[68:71], v9, s[36:39], s48 offen
  s_add_u32 s48, s48, 5504
  s_waitcnt vmcnt(1)
  buffer_load_dwordx4 v[72:75], v9, s[36:39], s48 offen
  s_add_u32 s48, s48, 5504
  s_waitcnt vmcnt(1)
  buffer_load_dwordx4 v[76:79], v9, s[36:39], s48 offen
  s_add_u32 s48, s48, 5504
  s_waitcnt vmcnt(1)
  buffer_load_dwordx4 v[80:83], v9, s[36:39], s48 offen
  s_add_u32 s48, s48, 5504
  s_waitcnt vmcnt(1)
  buffer_load_dwordx4 v[84:87], v9, s[36:39], s48 offen
  s_add_u32 s48, s48, 5504
  s_waitcnt vmcnt(1)
  buffer_load_dwordx4 v[88:91], v9, s[36:39], s48 offen
  s_add_u32 s48, s48, 5504
  s_waitcnt vmcnt(1)
  buffer_load_dwordx4 v[92:95], v9, s[36:39], s48 offen
  s_add_u32 s48, s48, 5504
  s_waitcnt vmcnt(1)
  buffer_load_dwordx4 v[96:99], v9, s[36:39], s48 offen
  s_add_u32 s48, s48, 5504
  s_waitcnt vmcnt(1)
  buffer_load_dwordx4 v[100:103], v9, s[36:39], s48 offen
  s_add_u32 s48, s48, 5504
  s_waitcnt vmcnt(1)
  buffer_load_dwordx4 v[104:107], v9, s[36:39], s48 offen
  s_add_u32 s48, s48, 5504
  s_waitcnt vmcnt(1)
  buffer_load_dwordx4 v[108:111], v9, s[36:39], s48 offen
  s_add_u32 s48, s48, 5504
  s_waitcnt vmcnt(1)
  buffer_load_dwordx4 v[112:115], v9, s[36:39], s48 offen
  s_add_u32 s48, s48, 5504
  s_waitcnt vmcnt(1)
  buffer_load_dwordx4 v[116:119], v9, s[36:39], s48 offen
  s_add_u32 s48, s48, 5504
  s_waitcnt vmcnt(1)
  buffer_load_dwordx4 v[120:123], v9, s[36:39], s48 offen
  s_add_u32 s48, s48, 5504
  s_waitcnt vmcnt(1)
  buffer_load_dwordx4 v[124:127], v9, s[36:39], s48 offen
  s_add_u32 s48, s48, 5504
  s_mov_b32 s44, s18
  s_mov_b32 s45, s19
  s_add_u32 s51, s55, s56
  s_lshl_b32 s46, s51, 4
  s_mov_b32 s47, 0x20000
  v_lshl_add_u32 v60, v3, 2, v2
  s_lshl_b32 s51, s55, 4
  v_lshlrev_b32 v15, 1, v60
  v_add_u32 v15, s51, v15
  buffer_load_ushort v46, v15, s[44:47], 0 offen
  v_mov_b32_dpp v44, v36 row_newbcast:0 row_mask:0xf bank_mask:0x3
  v_mov_b32_dpp v44, v37 row_newbcast:0 row_mask:0xf bank_mask:0xc
  v_and_b32 v16, v44, v32
  v_and_b32 v17, v44, v33
  v_and_b32 v18, v44, v34
  v_and_b32 v19, v44, v35
  s_waitcnt vmcnt(16)
  s_nop 0
  v_mfma_f32_16x16x32_bf16 v[28:31], v[16:19], v[64:67], v[28:31]
  v_mov_b32_dpp v45, v36 row_newbcast:1 row_mask:0xf bank_mask:0x3
  v_mov_b32_dpp v45, v37 row_newbcast:1 row_mask:0xf bank_mask:0xc
  v_and_b32 v20, v45, v32
  v_and_b32 v21, v45, v33
  v_and_b32 v22, v45, v34
  v_and_b32 v23, v45, v35
  s_waitcnt vmcnt(15)
  s_nop 0
  v_mfma_f32_16x16x32_bf16 v[28:31], v[20:23], v[68:71], v[28:31]
  v_mov_b32_dpp v44, v36 row_newbcast:2 row_mask:0xf bank_mask:0x3
  v_mov_b32_dpp v44, v37 row_newbcast:2 row_mask:0xf bank_mask:0xc
  v_and_b32 v16, v44, v32
  v_and_b32 v17, v44, v33
  v_and_b32 v18, v44, v34
  v_and_b32 v19, v44, v35
  s_waitcnt vmcnt(14)
  s_nop 0
  v_mfma_f32_16x16x32_bf16 v[28:31], v[16:19], v[72:75], v[28:31]
  v_mov_b32_dpp v45, v36 row_newbcast:3 row_mask:0xf bank_mask:0x3
  v_mov_b32_dpp v45, v37 row_newbcast:3 row_mask:0xf bank_mask:0xc
  v_and_b32 v20, v45, v32
  v_and_b32 v21, v45, v33
  v_and_b32 v22, v45, v34
  v_and_b32 v23, v45, v35
  s_waitcnt vmcnt(13)
  s_nop 0
  v_mfma_f32_16x16x32_bf16 v[28:31], v[20:23], v[76:79], v[28:31]
  v_mov_b32_dpp v44, v36 row_newbcast:4 row_mask:0xf bank_mask:0x3
  v_mov_b32_dpp v44, v37 row_newbcast:4 row_mask:0xf bank_mask:0xc
  v_and_b32 v16, v44, v32
  v_and_b32 v17, v44, v33
  v_and_b32 v18, v44, v34
  v_and_b32 v19, v44, v35
  s_waitcnt vmcnt(12)
  s_nop 0
  v_mfma_f32_16x16x32_bf16 v[28:31], v[16:19], v[80:83], v[28:31]
  v_mov_b32_dpp v45, v36 row_newbcast:5 row_mask:0xf bank_mask:0x3
  v_mov_b32_dpp v45, v37 row_newbcast:5 row_mask:0xf bank_mask:0xc
  v_and_b32 v20, v45, v32
  v_and_b32 v21, v45, v33
  v_and_b32 v22, v45, v34
  v_and_b32 v23, v45, v35
  s_waitcnt vmcnt(11)
  s_nop 0
  v_mfma_f32_16x16x32_bf16 v[28:31], v[20:23], v[84:87], v[28:31]
  v_mov_b32_dpp v44, v36 row_newbcast:6 row_mask:0xf bank_mask:0x3
  v_mov_b32_dpp v44, v37 row_newbcast:6 row_mask:0xf bank_mask:0xc
  v_and_b32 v16, v44, v32
  v_and_b32 v17, v44, v33
  v_and_b32 v18, v44, v34
  v_and_b32 v19, v44, v35
  s_waitcnt vmcnt(10)
  s_nop 0
  v_mfma_f32_16x16x32_bf16 v[28:31], v[16:19], v[88:91], v[28:31]
  v_mov_b32_dpp v45, v36 row_newbcast:7 row_mask:0xf bank_mask:0x3
  v_mov_b32_dpp v45, v37 row_newbcast:7 row_mask:0xf bank_mask:0xc
  v_and_b32 v20, v45, v32
  v_and_b32 v21, v45, v33
  v_and_b32 v22, v45, v34
  v_and_b32 v23, v45, v35
  s_waitcnt vmcnt(9)
  s_nop 0
  v_mfma_f32_16x16x32_bf16 v[28:31], v[20:23], v[92:95], v[28:31]
  v_mov_b32_dpp v44, v36 row_newbcast:8 row_mask:0xf bank_mask:0x3
  v_mov_b32_dpp v44, v37 row_newbcast:8 row_mask:0xf bank_mask:0xc
  v_and_b32 v16, v44, v32
  v_and_b32 v17, v44, v33
  v_and_b32 v18, v44, v34
  v_and_b32 v19, v44, v35
  s_waitcnt vmcnt(8)
  s_nop 0
  v_mfma_f32_16x16x32_bf16 v[28:31], v[16:19], v[96:99], v[28:31]
  v_mov_b32_dpp v45, v36 row_newbcast:9 row_mask:0xf bank_mask:0x3
  v_mov_b32_dpp v45, v37 row_newbcast:9 row_mask:0xf bank_mask:0xc
  v_and_b32 v20, v45, v32
  v_and_b32 v21, v45, v33
  v_and_b32 v22, v45, v34
  v_and_b32 v23, v45, v35
  s_waitcnt vmcnt(7)
  s_nop 0
  v_mfma_f32_16x16x32_bf16 v[28:31], v[20:23], v[100:103], v[28:31]
  v_mov_b32_dpp v44, v36 row_newbcast:10 row_mask:0xf bank_mask:0x3
  v_mov_b32_dpp v44, v37 row_newbcast:10 row_mask:0xf bank_mask:0xc
  v_and_b32 v16, v44, v32
  v_and_b32 v17, v44, v33
  v_and_b32 v18, v44, v34
  v_and_b32 v19, v44, v35
  s_waitcnt vmcnt(6)
  s_nop 0
  v_mfma_f32_16x16x32_bf16 v[28:31], v[16:19], v[104:107], v[28:31]
  v_mov_b32_dpp v45, v36 row_newbcast:11 row_mask:0xf bank_mask:0x3
  v_mov_b32_dpp v45, v37 row_newbcast:11 row_mask:0xf bank_mask:0xc
  v_and_b32 v20, v45, v32
  v_and_b32 v21, v45, v33
  v_and_b32 v22, v45, v34
  v_and_b32 v23, v45, v35
  s_waitcnt vmcnt(5)
  s_nop 0
  v_mfma_f32_16x16x32_bf16 v[28:31], v[20:23], v[108:111], v[28:31]
  v_mov_b32_dpp v44, v36 row_newbcast:12 row_mask:0xf bank_mask:0x3
  v_mov_b32_dpp v44, v37 row_newbcast:12 row_mask:0xf bank_mask:0xc
  v_and_b32 v16, v44, v32
  v_and_b32 v17, v44, v33
  v_and_b32 v18, v44, v34
  v_and_b32 v19, v44, v35
  s_waitcnt vmcnt(4)
  s_nop 0
  v_mfma_f32_16x16x32_bf16 v[28:31], v[16:19], v[112:115], v[28:31]
  v_mov_b32_dpp v45, v36 row_newbcast:13 row_mask:0xf bank_mask:0x3
  v_mov_b32_dpp v45, v37 row_newbcast:13 row_mask:0xf bank_mask:0xc
  v_and_b32 v20, v45, v32
  v_and_b32 v21, v45, v33
  v_and_b32 v22, v45, v34
  v_and_b32 v23, v45, v35
  s_waitcnt vmcnt(3)
  s_nop 0
  v_mfma_f32_16x16x32_bf16 v[28:31], v[20:23], v[116:119], v[28:31]
  v_mov_b32_dpp v44, v36 row_newbcast:14 row_mask:0xf bank_mask:0x3
  v_mov_b32_dpp v44, v37 row_newbcast:14 row_mask:0xf bank_mask:0xc
  v_and_b32 v16, v44, v32
  v_and_b32 v17, v44, v33
  v_and_b32 v18, v44, v34
  v_and_b32 v19, v44, v35
  s_waitcnt vmcnt(2)
  s_nop 0
  v_mfma_f32_16x16x32_bf16 v[28:31], v[16:19], v[120:123], v[28:31]
  v_mov_b32_dpp v45, v36 row_newbcast:15 row_mask:0xf bank_mask:0x3
  v_mov_b32_dpp v45, v37 row_newbcast:15 row_mask:0xf bank_mask:0xc
  v_and_b32 v20, v45, v32
  v_and_b32 v21, v45, v33
  v_and_b32 v22, v45, v34
  v_and_b32 v23, v45, v35
  s_waitcnt vmcnt(1)
  s_nop 0
  v_mfma_f32_16x16x32_bf16 v[28:31], v[20:23], v[124:127], v[28:31]
  v_lshrrev_b32 v10, 1, v2
  v_lshrrev_b32 v11, 3, v3
  v_cmp_eq_u32 vcc, v10, v11
  v_lshlrev_b32 v10, 8, v10
  v_and_b32 v11, 7, v3
  v_lshl_add_u32 v10, v11, 5, v10
  v_and_b32 v11, 1, v2
  v_lshl_add_u32 v10, v11, 4, v10
  s_lshl_b32 s50, s57, 9
  v_add_u32 v10, s50, v10
  s_and_saveexec_b64 s[62:63], vcc
  ds_write_b128 v10, v[28:31] offset:2048
  s_mov_b64 exec, 1
  v_mov_b32 v11, 1
  v_mov_b32 v12, 6400
  s_waitcnt lgkmcnt(0)
  ds_add_u32 v12, v11
  s_mov_b64 exec, -1
  s_lshl_b32 s50, s55, 13
  s_lshl_b32 s52, s57, 8
  v_lshlrev_b32 v9, 10, v2
  v_lshl_add_u32 v9, v3, 4, v9
  v_add_u32 v9, s50, v9
  v_add_u32 v9, s52, v9
  s_mov_b32 s36, s20
  s_mov_b32 s37, s21
  s_lshl_b32 s51, s56, 13
  s_add_u32 s38, s50, s51
  s_mov_b32 s39, 0x20000
  s_lshl_b32 s50, s3, 17
  s_add_u32 s50, s50, s52
  v_lshlrev_b32 v8, 15, v2
  v_lshl_add_u32 v8, v3, 4, v8
  v_add_u32 v8, s50, v8
  v_lshlrev_b32 v15, 2, v60
  s_mov_b32 s48, 0
  s_mov_b32 s32, s12
  s_mov_b32 s33, s13
  s_mov_b32 s34, 4194304
  s_mov_b32 s35, 0x20000
  s_waitcnt vmcnt(1)
  buffer_load_dwordx4 v[64:67], v9, s[36:39], s48 offen
  s_add_u32 s48, s48, 4096
  s_waitcnt vmcnt(1)
  buffer_load_dwordx4 v[68:71], v9, s[36:39], s48 offen
  s_add_u32 s48, s48, 4096
  s_waitcnt vmcnt(1)
  buffer_load_dwordx4 v[72:75], v9, s[36:39], s48 offen
  s_add_u32 s48, s48, 4096
  s_waitcnt vmcnt(1)
  buffer_load_dwordx4 v[76:79], v9, s[36:39], s48 offen
  s_add_u32 s48, s48, 4096
  s_waitcnt vmcnt(1)
  buffer_load_dwordx4 v[80:83], v9, s[36:39], s48 offen
  s_add_u32 s48, s48, 4096
  s_waitcnt vmcnt(1)
  buffer_load_dwordx4 v[84:87], v9, s[36:39], s48 offen
  s_add_u32 s48, s48, 4096
  s_waitcnt vmcnt(1)
  buffer_load_dwordx4 v[88:91], v9, s[36:39], s48 offen
  s_add_u32 s48, s48, 4096
  s_waitcnt vmcnt(1)
  buffer_load_dwordx4 v[92:95], v9, s[36:39], s48 offen
  s_add_u32 s48, s48, 4096
  s_waitcnt vmcnt(1)
  buffer_load_dwordx4 v[96:99], v9, s[36:39], s48 offen
  s_add_u32 s48, s48, 4096
  s_waitcnt vmcnt(1)
  buffer_load_dwordx4 v[100:103], v9, s[36:39], s48 offen
  s_add_u32 s48, s48, 4096
  s_waitcnt vmcnt(1)
  buffer_load_dwordx4 v[104:107], v9, s[36:39], s48 offen
  s_add_u32 s48, s48, 4096
  s_waitcnt vmcnt(1)
  buffer_load_dwordx4 v[108:111], v9, s[36:39], s48 offen
  s_add_u32 s48, s48, 4096
  s_mov_b32 s48, 0
  s_waitcnt vmcnt(1)
  buffer_load_dwordx4 v[128:131], v8, s[32:35], s48 offen offset:0
  s_waitcnt vmcnt(1)
  buffer_load_dwordx4 v[132:135], v8, s[32:35], s48 offen offset:1024
  s_waitcnt vmcnt(1)
  buffer_load_dwordx4 v[136:139], v8, s[32:35], s48 offen offset:2048
  s_waitcnt vmcnt(1)
  buffer_load_dwordx4 v[140:143], v8, s[32:35], s48 offen offset:3072
  s_add_u32 s48, s48, 4096
  s_waitcnt vmcnt(1)
  buffer_load_dwordx4 v[144:147], v8, s[32:35], s48 offen offset:0
  s_waitcnt vmcnt(1)
  buffer_load_dwordx4 v[148:151], v8, s[32:35], s48 offen offset:1024
  s_waitcnt vmcnt(1)
  buffer_load_dwordx4 v[152:155], v8, s[32:35], s48 offen offset:2048
  s_waitcnt vmcnt(1)
  buffer_load_dwordx4 v[156:159], v8, s[32:35], s48 offen offset:3072
  s_add_u32 s48, s48, 4096
  s_waitcnt vmcnt(1)
  buffer_load_dwordx4 v[160:163], v8, s[32:35], s48 offen offset:0
  s_waitcnt vmcnt(1)
  buffer_load_dwordx4 v[164:167], v8, s[32:35], s48 offen offset:1024
  s_waitcnt vmcnt(1)
  buffer_load_dwordx4 v[168:171], v8, s[32:35], s48 offen offset:2048
  s_waitcnt vmcnt(1)
  buffer_load_dwordx4 v[172:175], v8, s[32:35], s48 offen offset:3072
  s_add_u32 s48, s48, 4096
  s_waitcnt vmcnt(1)
  buffer_load_dwordx4 v[176:179], v8, s[32:35], s48 offen offset:0
  s_waitcnt vmcnt(1)
  buffer_load_dwordx4 v[180:183], v8, s[32:35], s48 offen offset:1024
  s_waitcnt vmcnt(1)
  buffer_load_dwordx4 v[184:187], v8, s[32:35], s48 offen offset:2048
  s_waitcnt vmcnt(1)
  buffer_load_dwordx4 v[188:191], v8, s[32:35], s48 offen offset:3072
  s_add_u32 s48, s48, 4096
  s_waitcnt vmcnt(1)
  buffer_load_dwordx4 v[192:195], v8, s[32:35], s48 offen offset:0
  s_waitcnt vmcnt(1)
  buffer_load_dwordx4 v[196:199], v8, s[32:35], s48 offen offset:1024
  s_waitcnt vmcnt(1)
  buffer_load_dwordx4 v[200:203], v8, s[32:35], s48 offen offset:2048
  s_waitcnt vmcnt(1)
  buffer_load_dwordx4 v[204:207], v8, s[32:35], s48 offen offset:3072
  s_add_u32 s48, s48, 4096
  s_waitcnt vmcnt(1)
  buffer_load_dwordx4 v[208:211], v8, s[32:35], s48 offen offset:0
  s_waitcnt vmcnt(1)
  buffer_load_dwordx4 v[212:215], v8, s[32:35], s48 offen offset:1024
  s_waitcnt vmcnt(1)
  buffer_load_dwordx4 v[216:219], v8, s[32:35], s48 offen offset:2048
  s_waitcnt vmcnt(1)
  buffer_load_dwordx4 v[220:223], v8, s[32:35], s48 offen offset:3072
  s_add_u32 s48, s48, 4096
  s_waitcnt vmcnt(1)
  buffer_load_dwordx4 v[224:227], v8, s[32:35], s48 offen offset:0
  s_waitcnt vmcnt(1)
  buffer_load_dwordx4 v[228:231], v8, s[32:35], s48 offen offset:1024
  s_waitcnt vmcnt(1)
  buffer_load_dwordx4 v[232:235], v8, s[32:35], s48 offen offset:2048
  s_waitcnt vmcnt(1)
  buffer_load_dwordx4 v[236:239], v8, s[32:35], s48 offen offset:3072
  s_add_u32 s48, s48, 4096
  s_waitcnt vmcnt(1)
  buffer_load_dwordx4 v[240:243], v8, s[32:35], s48 offen offset:0
  s_waitcnt vmcnt(1)
  buffer_load_dwordx4 v[244:247], v8, s[32:35], s48 offen offset:1024
  s_waitcnt vmcnt(1)
  buffer_load_dwordx4 v[248:251], v8, s[32:35], s48 offen offset:2048
  s_waitcnt vmcnt(1)
  buffer_load_dwordx4 v[252:255], v8, s[32:35], s48 offen offset:3072
  s_add_u32 s48, s48, 4096
  v_mov_b32 v12, 6400
L_hwait:
  ds_read_b32 v11, v12
  s_waitcnt lgkmcnt(0)
  v_readfirstlane_b32 s51, v11
  s_nop 3
  s_cmp_ge_u32 s51, 4
  s_cbranch_scc1 L_hdone
  s_sleep 2
  s_branch L_hwait
L_hdone:
  ds_read_b32 v48, v15 offset:2048
  ds_read_b32 v49, v15 offset:2304
  ds_read_b32 v50, v15 offset:2560
  ds_read_b32 v51, v15 offset:2816
  ds_read_b32 v52, v15 offset:3072
  ds_read_b32 v53, v15 offset:3328
  ds_read_b32 v54, v15 offset:3584
  ds_read_b32 v55, v15 offset:3840
  s_waitcnt lgkmcnt(0)
  v_add_f32 v48, v48, v49
  v_add_f32 v50, v50, v51
  v_add_f32 v52, v52, v53
  v_add_f32 v54, v54, v55
  v_add_f32 v48, v48, v50
  v_add_f32 v52, v52, v54
  v_add_f32 v10, v48, v52
  v_cvt_pk_bf16_f32 v10, v10, v10
  v_lshlrev_b32 v10, 16, v10
  s_waitcnt vmcnt(44)
  v_lshlrev_b32 v46, 16, v46
  v_add_f32 v10, v10, v46
  v_cvt_pk_bf16_f32 v10, v10, v10
  v_lshlrev_b32 v10, 16, v10
  v_cmp_lt_f32 vcc, 0, v10
  s_lshl_b32 s51, s56, 3
  v_cmp_gt_u32 s[62:63], s51, v60
  s_nop 1
  s_and_b64 vcc, vcc, s[62:63]
  s_nop 1
  v_cndmask_b32 v10, 0, v10, vcc
  v_mul_f32 v10, v10, v10
  v_cvt_pk_bf16_f32 v47, v10, v10
  v_mov_b32 v24, 0
  v_mov_b32 v25, 0
  v_mov_b32 v26, 0
  v_mov_b32 v27, 0
  v_and_b32_dpp v16, v47, v4 row_newbcast:0 row_mask:0xf bank_mask:0xf
  v_and_b32_dpp v17, v47, v5 row_newbcast:0 row_mask:0xf bank_mask:0xf
  v_and_b32_dpp v18, v47, v6 row_newbcast:0 row_mask:0xf bank_mask:0xf
  v_and_b32_dpp v19, v47, v7 row_newbcast:0 row_mask:0xf bank_mask:0xf
  s_waitcnt vmcnt(43)
  s_nop 0
  v_mfma_f32_16x16x32_bf16 v[24:27], v[16:19], v[64:67], v[24:27]
  v_and_b32_dpp v20, v47, v4 row_newbcast:1 row_mask:0xf bank_mask:0xf
  v_and_b32_dpp v21, v47, v5 row_newbcast:1 row_mask:0xf bank_mask:0xf
  v_and_b32_dpp v22, v47, v6 row_newbcast:1 row_mask:0xf bank_mask:0xf
  v_and_b32_dpp v23, v47, v7 row_newbcast:1 row_mask:0xf bank_mask:0xf
  s_waitcnt vmcnt(42)
  s_nop 0
  v_mfma_f32_16x16x32_bf16 v[24:27], v[20:23], v[68:71], v[24:27]
  v_and_b32_dpp v16, v47, v4 row_newbcast:2 row_mask:0xf bank_mask:0xf
  v_and_b32_dpp v17, v47, v5 row_newbcast:2 row_mask:0xf bank_mask:0xf
  v_and_b32_dpp v18, v47, v6 row_newbcast:2 row_mask:0xf bank_mask:0xf
  v_and_b32_dpp v19, v47, v7 row_newbcast:2 row_mask:0xf bank_mask:0xf
  s_waitcnt vmcnt(41)
  s_nop 0
  v_mfma_f32_16x16x32_bf16 v[24:27], v[16:19], v[72:75], v[24:27]
  v_and_b32_dpp v20, v47, v4 row_newbcast:3 row_mask:0xf bank_mask:0xf
  v_and_b32_dpp v21, v47, v5 row_newbcast:3 row_mask:0xf bank_mask:0xf
  v_and_b32_dpp v22, v47, v6 row_newbcast:3 row_mask:0xf bank_mask:0xf
  v_and_b32_dpp v23, v47, v7 row_newbcast:3 row_mask:0xf bank_mask:0xf
  s_waitcnt vmcnt(40)
  s_nop 0
  v_mfma_f32_16x16x32_bf16 v[24:27], v[20:23], v[76:79], v[24:27]
  v_and_b32_dpp v16, v47, v4 row_newbcast:4 row_mask:0xf bank_mask:0xf
  v_and_b32_dpp v17, v47, v5 row_newbcast:4 row_mask:0xf bank_mask:0xf
  v_and_b32_dpp v18, v47, v6 row_newbcast:4 row_mask:0xf bank_mask:0xf
  v_and_b32_dpp v19, v47, v7 row_newbcast:4 row_mask:0xf bank_mask:0xf
  s_waitcnt vmcnt(39)
  s_nop 0
  v_mfma_f32_16x16x32_bf16 v[24:27], v[16:19], v[80:83], v[24:27]
  v_and_b32_dpp v20, v47, v4 row_newbcast:5 row_mask:0xf bank_mask:0xf
  v_and_b32_dpp v21, v47, v5 row_newbcast:5 row_mask:0xf bank_mask:0xf
  v_and_b32_dpp v22, v47, v6 row_newbcast:5 row_mask:0xf bank_mask:0xf
  v_and_b32_dpp v23, v47, v7 row_newbcast:5 row_mask:0xf bank_mask:0xf
  s_waitcnt vmcnt(38)
  s_nop 0
  v_mfma_f32_16x16x32_bf16 v[24:27], v[20:23], v[84:87], v[24:27]
  v_and_b32_dpp v16, v47, v4 row_newbcast:6 row_mask:0xf bank_mask:0xf
  v_and_b32_dpp v17, v47, v5 row_newbcast:6 row_mask:0xf bank_mask:0xf
  v_and_b32_dpp v18, v47, v6 row_newbcast:6 row_mask:0xf bank_mask:0xf
  v_and_b32_dpp v19, v47, v7 row_newbcast:6 row_mask:0xf bank_mask:0xf
  s_waitcnt vmcnt(37)
  s_nop 0
  v_mfma_f32_16x16x32_bf16 v[24:27], v[16:19], v[88:91], v[24:27]
  v_and_b32_dpp v20, v47, v4 row_newbcast:7 row_mask:0xf bank_mask:0xf
  v_and_b32_dpp v21, v47, v5 row_newbcast:7 row_mask:0xf bank_mask:0xf
  v_and_b32_dpp v22, v47, v6 row_newbcast:7 row_mask:0xf bank_mask:0xf
  v_and_b32_dpp v23, v47, v7 row_newbcast:7 row_mask:0xf bank_mask:0xf
  s_waitcnt vmcnt(36)
  s_nop 0
  v_mfma_f32_16x16x32_bf16 v[24:27], v[20:23], v[92:95], v[24:27]
  v_and_b32_dpp v16, v47, v4 row_newbcast:8 row_mask:0xf bank_mask:0xf
  v_and_b32_dpp v17, v47, v5 row_newbcast:8 row_mask:0xf bank_mask:0xf
  v_and_b32_dpp v18, v47, v6 row_newbcast:8 row_mask:0xf bank_mask:0xf
  v_and_b32_dpp v19, v47, v7 row_newbcast:8 row_mask:0xf bank_mask:0xf
  s_waitcnt vmcnt(35)
  s_nop 0
  v_mfma_f32_16x16x32_bf16 v[24:27], v[16:19], v[96:99], v[24:27]
  v_and_b32_dpp v20, v47, v4 row_newbcast:9 row_mask:0xf bank_mask:0xf
  v_and_b32_dpp v21, v47, v5 row_newbcast:9 row_mask:0xf bank_mask:0xf
  v_and_b32_dpp v22, v47, v6 row_newbcast:9 row_mask:0xf bank_mask:0xf
  v_and_b32_dpp v23, v47, v7 row_newbcast:9 row_mask:0xf bank_mask:0xf
  s_waitcnt vmcnt(34)
  s_nop 0
  v_mfma_f32_16x16x32_bf16 v[24:27], v[20:23], v[100:103], v[24:27]
  v_and_b32_dpp v16, v47, v4 row_newbcast:10 row_mask:0xf bank_mask:0xf
  v_and_b32_dpp v17, v47, v5 row_newbcast:10 row_mask:0xf bank_mask:0xf
  v_and_b32_dpp v18, v47, v6 row_newbcast:10 row_mask:0xf bank_mask:0xf
  v_and_b32_dpp v19, v47, v7 row_newbcast:10 row_mask:0xf bank_mask:0xf
  s_waitcnt vmcnt(33)
  s_nop 0
  v_mfma_f32_16x16x32_bf16 v[24:27], v[16:19], v[104:107], v[24:27]
  v_and_b32_dpp v20, v47, v4 row_newbcast:11 row_mask:0xf bank_mask:0xf
  v_and_b32_dpp v21, v47, v5 row_newbcast:11 row_mask:0xf bank_mask:0xf
  v_and_b32_dpp v22, v47, v6 row_newbcast:11 row_mask:0xf bank_mask:0xf
  v_and_b32_dpp v23, v47, v7 row_newbcast:11 row_mask:0xf bank_mask:0xf
  s_waitcnt vmcnt(32)
  s_nop 0
  v_mfma_f32_16x16x32_bf16 v[24:27], v[20:23], v[108:111], v[24:27]
  s_and_b32 s50, s3, 0x19
  s_cbranch_scc1 L_noclear
  s_cmp_lg_u32 s57, 0
  s_cbranch_scc1 L_noclear
  s_lshl_b32 s50, s31, 16
  s_add_u32 s44, s28, s50
  s_addc_u32 s45, s29, 0
  s_mov_b32 s46, 0x10000
  s_mov_b32 s47, 0x20000
  s_lshr_b32 s52, s3, 1
  s_lshl_b32 s50, s52, 9
  v_lshrrev_b32 v10, 5, v1
  v_lshlrev_b32 v10, 11, v10
  v_and_b32 v11, 31, v1
  v_lshl_add_u32 v10, v11, 4, v10
  v_add_u32 v10, s50, v10
  v_mov_b32 v64, -1
  v_mov_b32 v65, -1
  v_mov_b32 v66, -1
  v_mov_b32 v67, -1
  s_mov_b32 s48, 0
  buffer_store_dwordx4 v[64:67], v10, s[44:47], s48 offen sc1
  s_add_u32 s48, s48, 4096
  buffer_store_dwordx4 v[64:67], v10, s[44:47], s48 offen sc1
  s_add_u32 s48, s48, 4096
  buffer_store_dwordx4 v[64:67], v10, s[44:47], s48 offen sc1
  s_add_u32 s48, s48, 4096
  buffer_store_dwordx4 v[64:67], v10, s[44:47], s48 offen sc1
  s_add_u32 s48, s48, 4096
  buffer_store_dwordx4 v[64:67], v10, s[44:47], s48 offen sc1
  s_add_u32 s48, s48, 4096
  buffer_store_dwordx4 v[64:67], v10, s[44:47], s48 offen sc1
  s_add_u32 s48, s48, 4096
  buffer_store_dwordx4 v[64:67], v10, s[44:47], s48 offen sc1
  s_add_u32 s48, s48, 4096
  buffer_store_dwordx4 v[64:67], v10, s[44:47], s48 offen sc1
  s_add_u32 s48, s48, 4096
  buffer_store_dwordx4 v[64:67], v10, s[44:47], s48 offen sc1
  s_add_u32 s48, s48, 4096
  buffer_store_dwordx4 v[64:67], v10, s[44:47], s48 offen sc1
  s_add_u32 s48, s48, 4096
  buffer_store_dwordx4 v[64:67], v10, s[44:47], s48 offen sc1
  s_add_u32 s48, s48, 4096
  buffer_store_dwordx4 v[64:67], v10, s[44:47], s48 offen sc1
  s_add_u32 s48, s48, 4096
  buffer_store_dwordx4 v[64:67], v10, s[44:47], s48 offen sc1
  s_add_u32 s48, s48, 4096
  buffer_store_dwordx4 v[64:67], v10, s[44:47], s48 offen sc1
  s_add_u32 s48, s48, 4096
  buffer_store_dwordx4 v[64:67], v10, s[44:47], s48 offen sc1
  s_add_u32 s48, s48, 4096
  buffer_store_dwordx4 v[64:67], v10, s[44:47], s48 offen sc1
  s_add_u32 s48, s48, 4096
  s_lshl_b32 s50, s31, 2
  s_add_u32 s50, s50, s52
  s_lshl_b32 s50, s50, 3
  v_mov_b32 v10, s50
  v_mov_b32 v11, 1
  s_waitcnt vmcnt(0)
  s_mov_b64 exec, 1
  global_store_dword v10, v11, s[26:27] sc1
  s_mov_b64 exec, -1
L_noclear:
  s_lshl_b32 s50, s31, 2
  s_add_u32 s50, s50, s57
  s_lshl_b32 s50, s50, 3
  v_mov_b32 v13, s50
  s_lshl_b32 s50, s57, 3
  v_mov_b32 v14, s50
  s_waitcnt vmcnt(0)
  s_lshl_b32 s50, s2, 11
  s_lshl_b32 s51, s57, 9
  s_add_u32 s50, s50, s51
  v_add_u32 v39, s50, v43
  v_lshlrev_b32 v10, 7, v2
  v_lshl_add_u32 v10, v3, 3, v10
  v_mov_b32 v11, 0
  v_mov_b32 v12, -2
  s_mov_b32 s53, 0x3fb8aa3b
  v_mov_b32 v87, 6404
  s_mov_b32 s49, 0
L_mwait:
  ds_read_b32 v86, v87
  s_add_u32 s49, s49, 1
  s_waitcnt lgkmcnt(0)
  v_readfirstlane_b32 s51, v86
  s_cmp_gt_u32 s49, 0x400000
  s_cbranch_scc1 L_mdone
  s_cmp_ge_u32 s51, 4
  s_cbranch_scc1 L_mdone
  s_sleep 4
  s_branch L_mwait
L_mdone:
  ds_read_b128 v[72:75], v11 offset:6144
  ds_read_b128 v[76:79], v11 offset:6160
  ds_read_b32 v15, v14 offset:6176
  s_waitcnt lgkmcnt(0)
  v_max3_f32 v80, v72, v74, v76
  v_max_f32 v80, v80, v78
  v_sub_f32 v72, v72, v80
  v_sub_f32 v74, v74, v80
  v_sub_f32 v76, v76, v80
  v_sub_f32 v78, v78, v80
  v_mul_f32 v72, s53, v72
  v_mul_f32 v74, s53, v74
  v_mul_f32 v76, s53, v76
  v_mul_f32 v78, s53, v78
  v_exp_f32 v72, v72
  v_exp_f32 v74, v74
  v_exp_f32 v76, v76
  v_exp_f32 v78, v78
  v_mul_f32 v81, v72, v73
  v_fmac_f32 v81, v74, v75
  v_fmac_f32 v81, v76, v77
  v_fmac_f32 v81, v78, v79
  v_rcp_f32 v82, v81
  v_readfirstlane_b32 s51, v15
  v_fma_f32 v83, -v81, v82, 1.0
  v_fmac_f32 v82, v83, v82
  v_mul_f32 v72, v72, v82
  v_mul_f32 v74, v74, v82
  v_mul_f32 v76, v76, v82
  v_mul_f32 v78, v78, v82
  s_mov_b32 s49, 0
  s_cmp_lg_u32 s51, 0
  s_cbranch_scc1 L_fdone
L_fwait:
  global_load_dword v15, v13, s[26:27] sc1
  s_add_u32 s49, s49, 1
  s_waitcnt vmcnt(0)
  v_readfirstlane_b32 s51, v15
  s_cmp_gt_u32 s49, 0x40000
  s_cbranch_scc1 L_fdone
  s_cmp_lg_u32 s51, 0
  s_cbranch_scc1 L_fdone
  s_sleep 8
  s_branch L_fwait
L_fdone:
  s_barrier
  ds_read_b64 v[64:65], v10 offset:4096
  ds_read_b64 v[66:67], v10 offset:4608
  ds_read_b64 v[68:69], v10 offset:5120
  ds_read_b64 v[70:71], v10 offset:5632
  s_waitcnt lgkmcnt(3)
  v_mul_f32 v64, v72, v64
  v_mul_f32 v65, v72, v65
  s_waitcnt lgkmcnt(2)
  v_fmac_f32 v64, v74, v66
  v_fmac_f32 v65, v74, v67
  s_waitcnt lgkmcnt(1)
  v_fmac_f32 v64, v76, v68
  v_fmac_f32 v65, v76, v69
  s_waitcnt lgkmcnt(0)
  v_fmac_f32 v64, v78, v70
  v_fmac_f32 v65, v78, v71
  v_cvt_pk_bf16_f32 v36, v64, v64
  v_cvt_pk_bf16_f32 v37, v65, v65
  s_nop 0
  v_and_b32_dpp v16, v36, v4 row_newbcast:0 row_mask:0xf bank_mask:0xf
  v_and_b32_dpp v17, v36, v5 row_newbcast:0 row_mask:0xf bank_mask:0xf
  v_and_b32_dpp v18, v36, v6 row_newbcast:0 row_mask:0xf bank_mask:0xf
  v_and_b32_dpp v19, v36, v7 row_newbcast:0 row_mask:0xf bank_mask:0xf
  v_and_b32_dpp v20, v37, v4 row_newbcast:0 row_mask:0xf bank_mask:0xf
  v_and_b32_dpp v21, v37, v5 row_newbcast:0 row_mask:0xf bank_mask:0xf
  v_and_b32_dpp v22, v37, v6 row_newbcast:0 row_mask:0xf bank_mask:0xf
  v_and_b32_dpp v23, v37, v7 row_newbcast:0 row_mask:0xf bank_mask:0xf
  v_mfma_f32_16x16x32_bf16 v[24:27], v[16:19], v[128:131], v[24:27]
  v_and_b32_dpp v16, v36, v4 row_newbcast:1 row_mask:0xf bank_mask:0xf
  v_and_b32_dpp v17, v36, v5 row_newbcast:1 row_mask:0xf bank_mask:0xf
  v_and_b32_dpp v18, v36, v6 row_newbcast:1 row_mask:0xf bank_mask:0xf
  v_and_b32_dpp v19, v36, v7 row_newbcast:1 row_mask:0xf bank_mask:0xf
  v_mfma_f32_16x16x32_bf16 v[24:27], v[20:23], v[132:135], v[24:27]
  v_and_b32_dpp v20, v37, v4 row_newbcast:1 row_mask:0xf bank_mask:0xf
  v_and_b32_dpp v21, v37, v5 row_newbcast:1 row_mask:0xf bank_mask:0xf
  v_and_b32_dpp v22, v37, v6 row_newbcast:1 row_mask:0xf bank_mask:0xf
  v_and_b32_dpp v23, v37, v7 row_newbcast:1 row_mask:0xf bank_mask:0xf
  v_mfma_f32_16x16x32_bf16 v[24:27], v[16:19], v[136:139], v[24:27]
  v_and_b32_dpp v16, v36, v4 row_newbcast:2 row_mask:0xf bank_mask:0xf
  v_and_b32_dpp v17, v36, v5 row_newbcast:2 row_mask:0xf bank_mask:0xf
  v_and_b32_dpp v18, v36, v6 row_newbcast:2 row_mask:0xf bank_mask:0xf
  v_and_b32_dpp v19, v36, v7 row_newbcast:2 row_mask:0xf bank_mask:0xf
  v_mfma_f32_16x16x32_bf16 v[24:27], v[20:23], v[140:143], v[24:27]
  v_and_b32_dpp v20, v37, v4 row_newbcast:2 row_mask:0xf bank_mask:0xf
  v_and_b32_dpp v21, v37, v5 row_newbcast:2 row_mask:0xf bank_mask:0xf
  v_and_b32_dpp v22, v37, v6 row_newbcast:2 row_mask:0xf bank_mask:0xf
  v_and_b32_dpp v23, v37, v7 row_newbcast:2 row_mask:0xf bank_mask:0xf
  v_mfma_f32_16x16x32_bf16 v[24:27], v[16:19], v[144:147], v[24:27]
  v_and_b32_dpp v16, v36, v4 row_newbcast:3 row_mask:0xf bank_mask:0xf
  v_and_b32_dpp v17, v36, v5 row_newbcast:3 row_mask:0xf bank_mask:0xf
  v_and_b32_dpp v18, v36, v6 row_newbcast:3 row_mask:0xf bank_mask:0xf
  v_and_b32_dpp v19, v36, v7 row_newbcast:3 row_mask:0xf bank_mask:0xf
  v_mfma_f32_16x16x32_bf16 v[24:27], v[20:23], v[148:151], v[24:27]
  v_and_b32_dpp v20, v37, v4 row_newbcast:3 row_mask:0xf bank_mask:0xf
  v_and_b32_dpp v21, v37, v5 row_newbcast:3 row_mask:0xf bank_mask:0xf
  v_and_b32_dpp v22, v37, v6 row_newbcast:3 row_mask:0xf bank_mask:0xf
  v_and_b32_dpp v23, v37, v7 row_newbcast:3 row_mask:0xf bank_mask:0xf
  v_mfma_f32_16x16x32_bf16 v[24:27], v[16:19], v[152:155], v[24:27]
  v_and_b32_dpp v16, v36, v4 row_newbcast:4 row_mask:0xf bank_mask:0xf
  v_and_b32_dpp v17, v36, v5 row_newbcast:4 row_mask:0xf bank_mask:0xf
  v_and_b32_dpp v18, v36, v6 row_newbcast:4 row_mask:0xf bank_mask:0xf
  v_and_b32_dpp v19, v36, v7 row_newbcast:4 row_mask:0xf bank_mask:0xf
  v_mfma_f32_16x16x32_bf16 v[24:27], v[20:23], v[156:159], v[24:27]
  v_and_b32_dpp v20, v37, v4 row_newbcast:4 row_mask:0xf bank_mask:0xf
  v_and_b32_dpp v21, v37, v5 row_newbcast:4 row_mask:0xf bank_mask:0xf
  v_and_b32_dpp v22, v37, v6 row_newbcast:4 row_mask:0xf bank_mask:0xf
  v_and_b32_dpp v23, v37, v7 row_newbcast:4 row_mask:0xf bank_mask:0xf
  v_mfma_f32_16x16x32_bf16 v[24:27], v[16:19], v[160:163], v[24:27]
  v_and_b32_dpp v16, v36, v4 row_newbcast:5 row_mask:0xf bank_mask:0xf
  v_and_b32_dpp v17, v36, v5 row_newbcast:5 row_mask:0xf bank_mask:0xf
  v_and_b32_dpp v18, v36, v6 row_newbcast:5 row_mask:0xf bank_mask:0xf
  v_and_b32_dpp v19, v36, v7 row_newbcast:5 row_mask:0xf bank_mask:0xf
  v_mfma_f32_16x16x32_bf16 v[24:27], v[20:23], v[164:167], v[24:27]
  v_and_b32_dpp v20, v37, v4 row_newbcast:5 row_mask:0xf bank_mask:0xf
  v_and_b32_dpp v21, v37, v5 row_newbcast:5 row_mask:0xf bank_mask:0xf
  v_and_b32_dpp v22, v37, v6 row_newbcast:5 row_mask:0xf bank_mask:0xf
  v_and_b32_dpp v23, v37, v7 row_newbcast:5 row_mask:0xf bank_mask:0xf
  v_mfma_f32_16x16x32_bf16 v[24:27], v[16:19], v[168:171], v[24:27]
  v_and_b32_dpp v16, v36, v4 row_newbcast:6 row_mask:0xf bank_mask:0xf
  v_and_b32_dpp v17, v36, v5 row_newbcast:6 row_mask:0xf bank_mask:0xf
  v_and_b32_dpp v18, v36, v6 row_newbcast:6 row_mask:0xf bank_mask:0xf
  v_and_b32_dpp v19, v36, v7 row_newbcast:6 row_mask:0xf bank_mask:0xf
  v_mfma_f32_16x16x32_bf16 v[24:27], v[20:23], v[172:175], v[24:27]
  v_and_b32_dpp v20, v37, v4 row_newbcast:6 row_mask:0xf bank_mask:0xf
  v_and_b32_dpp v21, v37, v5 row_newbcast:6 row_mask:0xf bank_mask:0xf
  v_and_b32_dpp v22, v37, v6 row_newbcast:6 row_mask:0xf bank_mask:0xf
  v_and_b32_dpp v23, v37, v7 row_newbcast:6 row_mask:0xf bank_mask:0xf
  v_mfma_f32_16x16x32_bf16 v[24:27], v[16:19], v[176:179], v[24:27]
  v_and_b32_dpp v16, v36, v4 row_newbcast:7 row_mask:0xf bank_mask:0xf
  v_and_b32_dpp v17, v36, v5 row_newbcast:7 row_mask:0xf bank_mask:0xf
  v_and_b32_dpp v18, v36, v6 row_newbcast:7 row_mask:0xf bank_mask:0xf
  v_and_b32_dpp v19, v36, v7 row_newbcast:7 row_mask:0xf bank_mask:0xf
  v_mfma_f32_16x16x32_bf16 v[24:27], v[20:23], v[180:183], v[24:27]
  v_and_b32_dpp v20, v37, v4 row_newbcast:7 row_mask:0xf bank_mask:0xf
  v_and_b32_dpp v21, v37, v5 row_newbcast:7 row_mask:0xf bank_mask:0xf
  v_and_b32_dpp v22, v37, v6 row_newbcast:7 row_mask:0xf bank_mask:0xf
  v_and_b32_dpp v23, v37, v7 row_newbcast:7 row_mask:0xf bank_mask:0xf
  v_mfma_f32_16x16x32_bf16 v[24:27], v[16:19], v[184:187], v[24:27]
  v_and_b32_dpp v16, v36, v4 row_newbcast:8 row_mask:0xf bank_mask:0xf
  v_and_b32_dpp v17, v36, v5 row_newbcast:8 row_mask:0xf bank_mask:0xf
  v_and_b32_dpp v18, v36, v6 row_newbcast:8 row_mask:0xf bank_mask:0xf
  v_and_b32_dpp v19, v36, v7 row_newbcast:8 row_mask:0xf bank_mask:0xf
  v_mfma_f32_16x16x32_bf16 v[24:27], v[20:23], v[188:191], v[24:27]
  v_and_b32_dpp v20, v37, v4 row_newbcast:8 row_mask:0xf bank_mask:0xf
  v_and_b32_dpp v21, v37, v5 row_newbcast:8 row_mask:0xf bank_mask:0xf
  v_and_b32_dpp v22, v37, v6 row_newbcast:8 row_mask:0xf bank_mask:0xf
  v_and_b32_dpp v23, v37, v7 row_newbcast:8 row_mask:0xf bank_mask:0xf
  v_mfma_f32_16x16x32_bf16 v[24:27], v[16:19], v[192:195], v[24:27]
  v_and_b32_dpp v16, v36, v4 row_newbcast:9 row_mask:0xf bank_mask:0xf
  v_and_b32_dpp v17, v36, v5 row_newbcast:9 row_mask:0xf bank_mask:0xf
  v_and_b32_dpp v18, v36, v6 row_newbcast:9 row_mask:0xf bank_mask:0xf
  v_and_b32_dpp v19, v36, v7 row_newbcast:9 row_mask:0xf bank_mask:0xf
  v_mfma_f32_16x16x32_bf16 v[24:27], v[20:23], v[196:199], v[24:27]
  v_and_b32_dpp v20, v37, v4 row_newbcast:9 row_mask:0xf bank_mask:0xf
  v_and_b32_dpp v21, v37, v5 row_newbcast:9 row_mask:0xf bank_mask:0xf
  v_and_b32_dpp v22, v37, v6 row_newbcast:9 row_mask:0xf bank_mask:0xf
  v_and_b32_dpp v23, v37, v7 row_newbcast:9 row_mask:0xf bank_mask:0xf
  v_mfma_f32_16x16x32_bf16 v[24:27], v[16:19], v[200:203], v[24:27]
  v_and_b32_dpp v16, v36, v4 row_newbcast:10 row_mask:0xf bank_mask:0xf
  v_and_b32_dpp v17, v36, v5 row_newbcast:10 row_mask:0xf bank_mask:0xf
  v_and_b32_dpp v18, v36, v6 row_newbcast:10 row_mask:0xf bank_mask:0xf
  v_and_b32_dpp v19, v36, v7 row_newbcast:10 row_mask:0xf bank_mask:0xf
  v_mfma_f32_16x16x32_bf16 v[24:27], v[20:23], v[204:207], v[24:27]
  v_and_b32_dpp v20, v37, v4 row_newbcast:10 row_mask:0xf bank_mask:0xf
  v_and_b32_dpp v21, v37, v5 row_newbcast:10 row_mask:0xf bank_mask:0xf
  v_and_b32_dpp v22, v37, v6 row_newbcast:10 row_mask:0xf bank_mask:0xf
  v_and_b32_dpp v23, v37, v7 row_newbcast:10 row_mask:0xf bank_mask:0xf
  v_mfma_f32_16x16x32_bf16 v[24:27], v[16:19], v[208:211], v[24:27]
  v_and_b32_dpp v16, v36, v4 row_newbcast:11 row_mask:0xf bank_mask:0xf
  v_and_b32_dpp v17, v36, v5 row_newbcast:11 row_mask:0xf bank_mask:0xf
  v_and_b32_dpp v18, v36, v6 row_newbcast:11 row_mask:0xf bank_mask:0xf
  v_and_b32_dpp v19, v36, v7 row_newbcast:11 row_mask:0xf bank_mask:0xf
  v_mfma_f32_16x16x32_bf16 v[24:27], v[20:23], v[212:215], v[24:27]
  v_and_b32_dpp v20, v37, v4 row_newbcast:11 row_mask:0xf bank_mask:0xf
  v_and_b32_dpp v21, v37, v5 row_newbcast:11 row_mask:0xf bank_mask:0xf
  v_and_b32_dpp v22, v37, v6 row_newbcast:11 row_mask:0xf bank_mask:0xf
  v_and_b32_dpp v23, v37, v7 row_newbcast:11 row_mask:0xf bank_mask:0xf
  v_mfma_f32_16x16x32_bf16 v[24:27], v[16:19], v[216:219], v[24:27]
  v_and_b32_dpp v16, v36, v4 row_newbcast:12 row_mask:0xf bank_mask:0xf
  v_and_b32_dpp v17, v36, v5 row_newbcast:12 row_mask:0xf bank_mask:0xf
  v_and_b32_dpp v18, v36, v6 row_newbcast:12 row_mask:0xf bank_mask:0xf
  v_and_b32_dpp v19, v36, v7 row_newbcast:12 row_mask:0xf bank_mask:0xf
  v_mfma_f32_16x16x32_bf16 v[24:27], v[20:23], v[220:223], v[24:27]
  v_and_b32_dpp v20, v37, v4 row_newbcast:12 row_mask:0xf bank_mask:0xf
  v_and_b32_dpp v21, v37, v5 row_newbcast:12 row_mask:0xf bank_mask:0xf
  v_and_b32_dpp v22, v37, v6 row_newbcast:12 row_mask:0xf bank_mask:0xf
  v_and_b32_dpp v23, v37, v7 row_newbcast:12 row_mask:0xf bank_mask:0xf
  v_mfma_f32_16x16x32_bf16 v[24:27], v[16:19], v[224:227], v[24:27]
  v_and_b32_dpp v16, v36, v4 row_newbcast:13 row_mask:0xf bank_mask:0xf
  v_and_b32_dpp v17, v36, v5 row_newbcast:13 row_mask:0xf bank_mask:0xf
  v_and_b32_dpp v18, v36, v6 row_newbcast:13 row_mask:0xf bank_mask:0xf
  v_and_b32_dpp v19, v36, v7 row_newbcast:13 row_mask:0xf bank_mask:0xf
  v_mfma_f32_16x16x32_bf16 v[24:27], v[20:23], v[228:231], v[24:27]
  v_and_b32_dpp v20, v37, v4 row_newbcast:13 row_mask:0xf bank_mask:0xf
  v_and_b32_dpp v21, v37, v5 row_newbcast:13 row_mask:0xf bank_mask:0xf
  v_and_b32_dpp v22, v37, v6 row_newbcast:13 row_mask:0xf bank_mask:0xf
  v_and_b32_dpp v23, v37, v7 row_newbcast:13 row_mask:0xf bank_mask:0xf
  v_mfma_f32_16x16x32_bf16 v[24:27], v[16:19], v[232:235], v[24:27]
  v_and_b32_dpp v16, v36, v4 row_newbcast:14 row_mask:0xf bank_mask:0xf
  v_and_b32_dpp v17, v36, v5 row_newbcast:14 row_mask:0xf bank_mask:0xf
  v_and_b32_dpp v18, v36, v6 row_newbcast:14 row_mask:0xf bank_mask:0xf
  v_and_b32_dpp v19, v36, v7 row_newbcast:14 row_mask:0xf bank_mask:0xf
  v_mfma_f32_16x16x32_bf16 v[24:27], v[20:23], v[236:239], v[24:27]
  v_and_b32_dpp v20, v37, v4 row_newbcast:14 row_mask:0xf bank_mask:0xf
  v_and_b32_dpp v21, v37, v5 row_newbcast:14 row_mask:0xf bank_mask:0xf
  v_and_b32_dpp v22, v37, v6 row_newbcast:14 row_mask:0xf bank_mask:0xf
  v_and_b32_dpp v23, v37, v7 row_newbcast:14 row_mask:0xf bank_mask:0xf
  v_mfma_f32_16x16x32_bf16 v[24:27], v[16:19], v[240:243], v[24:27]
  v_and_b32_dpp v16, v36, v4 row_newbcast:15 row_mask:0xf bank_mask:0xf
  v_and_b32_dpp v17, v36, v5 row_newbcast:15 row_mask:0xf bank_mask:0xf
  v_and_b32_dpp v18, v36, v6 row_newbcast:15 row_mask:0xf bank_mask:0xf
  v_and_b32_dpp v19, v36, v7 row_newbcast:15 row_mask:0xf bank_mask:0xf
  v_mfma_f32_16x16x32_bf16 v[24:27], v[20:23], v[244:247], v[24:27]
  v_and_b32_dpp v20, v37, v4 row_newbcast:15 row_mask:0xf bank_mask:0xf
  v_and_b32_dpp v21, v37, v5 row_newbcast:15 row_mask:0xf bank_mask:0xf
  v_and_b32_dpp v22, v37, v6 row_newbcast:15 row_mask:0xf bank_mask:0xf
  v_and_b32_dpp v23, v37, v7 row_newbcast:15 row_mask:0xf bank_mask:0xf
  v_mfma_f32_16x16x32_bf16 v[24:27], v[16:19], v[248:251], v[24:27]
  s_nop 0
  v_mfma_f32_16x16x32_bf16 v[24:27], v[20:23], v[252:255], v[24:27]
  s_nop 7
  v_min_u32 v24, v12, v24
  v_min_u32 v25, v12, v25
  v_min_u32 v26, v12, v26
  v_min_u32 v27, v12, v27
  s_mov_b64 exec, s[64:65]
  global_store_dwordx4 v39, v[24:27], s[28:29] sc1
  s_mov_b64 exec, -1
L_end:
  s_endpgm
.section .rodata,"a"
.p2align 6
.amdhsa_kernel parallel_sum__gqa_block_cached__dense_activation_squared_relu__decode_kernel
  .amdhsa_next_free_vgpr 256
  .amdhsa_next_free_sgpr 72
  .amdhsa_accum_offset 256
  .amdhsa_group_segment_fixed_size 0
  .amdhsa_kernarg_size 104
  .amdhsa_user_sgpr_count 2
  .amdhsa_user_sgpr_kernarg_segment_ptr 1
  .amdhsa_system_sgpr_workgroup_id_x 1
  .amdhsa_float_denorm_mode_32 3
.end_amdhsa_kernel
```
